```python
import torch

def _softmax(x, axis=-1):
    return torch.softmax(x, dim=axis)
def _gelu(x):
    return torch.nn.functional.gelu(x, approximate="tanh")
def _silu(x):
    return torch.nn.functional.silu(x)
def _sigmoid(x):
    return torch.sigmoid(x)
def _layernorm(x, axis=-1, eps=1e-5):
    m = x.mean(dim=axis, keepdim=True)
    v = x.var(dim=axis, keepdim=True, unbiased=False)
    return (x - m) / torch.sqrt(v + eps)
def _scatter_add(tgt, idx, src, axis=0):
    return tgt.clone().index_add_(axis, idx, src)
def _segment_sum(src, seg, n):
    out = torch.zeros((n,) + src.shape[1:], dtype=src.dtype)
    return out.index_add_(0, seg, src)
def _pad(x, pw):
    flat = tuple(v for pair in reversed(pw) for v in pair)
    return torch.nn.functional.pad(x, flat)

kernel_name = 'interleave_layers__softmax_full_mha__glu_gated_glu__prompt'

def setup_inputs():

    _w = (lambda a: (lambda t: t.to(torch.bfloat16) if t.is_floating_point() else t)(torch.as_tensor(a)))
    def _A_setup():
        B, S, D = 1, 2048, 448
        return {
            "x": _w((lambda *s: torch.randn(*s, dtype=torch.bfloat16) * 0.05)(B, S, D)),
            "wqkv": _w((lambda *s: torch.randn(*s, dtype=torch.bfloat16) * 0.05)(D, 3 * D)),
            "wo": _w((lambda *s: torch.randn(*s, dtype=torch.bfloat16) * 0.05)(D, D)),
        }
    _A_in = _A_setup()

    def _B_setup():
        B, S, D, F = 1, 2048, 448, 1792
        return {
            "x": _w((lambda *s: torch.randn(*s, dtype=torch.bfloat16) * 0.05)(B, S, D)),
            "w_gate": _w((lambda *s: torch.randn(*s, dtype=torch.bfloat16) * 0.05)(D, F)),
            "w_up": _w((lambda *s: torch.randn(*s, dtype=torch.bfloat16) * 0.05)(D, F)),
            "w_down": _w((lambda *s: torch.randn(*s, dtype=torch.bfloat16) * 0.05)(F, D)),
        }
    _B_in = _B_setup()

    return {
        "A_x": _A_in["x"],
        "A_wqkv": _A_in["wqkv"],
        "A_wo": _A_in["wo"],
        "B_x": _B_in["x"],
        "B_w_gate": _B_in["w_gate"],
        "B_w_up": _B_in["w_up"],
        "B_w_down": _B_in["w_down"],
    }

def reference(A_x, A_wqkv, A_wo, B_x, B_w_gate, B_w_up, B_w_down):
    def _A_ref(x, wqkv, wo):
        B, S, D = x.shape
        H = 16; Dh = D // H
        qkv = (lambda x, *d: x.permute(*d))((x @ wqkv).reshape(B, S, 3, H, Dh), 2, 0, 3, 1, 4)
        q, k, v = qkv[0], qkv[1], qkv[2]
        scale = Dh ** -0.5
        scores = torch.einsum("bhqd,bhkd->bhqk", q, k) * scale
        p = _softmax(scores, axis=-1)
        o = torch.einsum("bhqk,bhkd->bhqd", p, v)
        return (lambda x, *d: x.permute(*d))(o, 0, 2, 1, 3).reshape(B, S, D) @ wo

    def _B_ref(x, w_gate, w_up, w_down):
        g = torch.einsum("bsd,df->bsf", x, w_gate)
        u = torch.einsum("bsd,df->bsf", x, w_up)
        h = _sigmoid(g) * u
        return torch.einsum("bsf,fd->bsd", h, w_down)

    x = A_x
    x = x + _A_ref(_layernorm(x, axis=-1), A_wqkv, A_wo)
    x = x + _B_ref(_layernorm(x, axis=-1), B_w_gate, B_w_up, B_w_down)
    x = x + _A_ref(_layernorm(x, axis=-1), A_wqkv, A_wo)
    x = x + _B_ref(_layernorm(x, axis=-1), B_w_gate, B_w_up, B_w_down)
    return x
```

```asm
; @launch kernel=mega_kernel grid=(256,1,1) block=(256,1,1) lds=148480
.amdgcn_target "amdgcn-amd-amdhsa--gfx950"
.text
.globl mega_kernel
.p2align 8
.type mega_kernel,@function
mega_kernel:
  s_load_dwordx4 s[4:7], s[0:1], 0
  s_load_dwordx2 s[8:9], s[0:1], 16
  s_load_dwordx4 s[12:15], s[0:1], 32
  s_load_dwordx2 s[16:17], s[0:1], 48
  s_load_dwordx2 s[18:19], s[0:1], 72
  s_load_dwordx2 s[10:11], s[0:1], 64
  s_cmp_ge_u32 s2, 256
  s_cbranch_scc1 mega_end
  s_and_b32 s41, s2, 7
  s_lshr_b32 s42, s2, 3
  s_lshr_b32 s21, s41, 1
  s_lshl_b32 s21, s21, 2
  s_lshr_b32 s43, s42, 3
  s_add_u32 s21, s21, s43
  s_and_b32 s23, s41, 1
  s_and_b32 s22, s42, 7
  s_lshl_b32 s57, s23, 3
  s_add_u32 s57, s57, s22
  v_lshrrev_b32 v1, 6, v0
  v_and_b32 v2, 31, v0
  v_readfirstlane_b32 s20, v1
  v_bfe_u32 v3, v0, 5, 1
  v_and_b32 v4, 63, v0
  v_lshlrev_b32 v4, 4, v4
  s_waitcnt lgkmcnt(0)
  s_mov_b32 s24, s18
  s_and_b32 s25, s19, 0xffff
  s_mov_b32 s26, 50331648
  s_mov_b32 s27, 0x20000
  s_mov_b32 s52, s10
  s_and_b32 s53, s11, 0xffff
  s_mov_b32 s54, 256
  s_mov_b32 s55, 0x20000
  s_mov_b32 s28, s4
  s_and_b32 s29, s5, 0xffff
  s_mov_b32 s30, 1835008
  s_mov_b32 s31, 0x20000
  s_lshr_b32 s41, s57, 2
  s_lshl_b32 s42, s21, 2
  s_add_u32 s41, s41, s42
  s_and_b32 s42, s57, 3
  s_lshl_b32 s42, s42, 2
  s_add_u32 s58, s42, s20
  s_mul_i32 s59, s41, 28672
  s_lshl_b32 s43, s58, 6
  s_add_u32 s42, s59, s43
  s_lshl_b32 s43, s58, 11
  s_add_u32 s59, s59, s43
  s_lshl_b32 s60, s41, 12
  s_lshl_b32 s43, s58, 8
  s_add_u32 s60, s60, s43
  s_add_u32 s60, s60, 34603008
  v_mul_u32_u24 v5, 896, v2
  v_lshl_add_u32 v5, v3, 3, v5
  s_cmp_ge_u32 s58, 14
  s_cbranch_scc1 prep_nx
  buffer_load_dwordx2 v[144:145], v5, s[28:31], s42 offen offset:0
  buffer_load_dwordx2 v[146:147], v5, s[28:31], s42 offen offset:16
  buffer_load_dwordx2 v[148:149], v5, s[28:31], s42 offen offset:32
  buffer_load_dwordx2 v[150:151], v5, s[28:31], s42 offen offset:48
prep_nx:
  v_mov_b32 v1, 0
  s_cmp_ge_u32 s2, 230
  s_cbranch_scc1 prep_idle
  s_mov_b32 s31, 0x20000
  s_mov_b32 s37, 1
  s_mov_b32 s38, 7
  s_mov_b32 s39, 32
  s_mov_b32 s40, 0
  s_mov_b32 s50, 0
  s_mov_b32 s36, 1024
  s_mul_i32 s34, s20, 7
  s_cmp_ge_u32 s2, 48
  s_cbranch_scc1 prep_t1
  s_mov_b32 s28, s6
  s_and_b32 s29, s7, 0xffff
  s_mov_b32 s30, 1204224
  s_mov_b32 s32, 2688
  s_mul_i32 s33, s2, 56
  s_and_b32 s50, s33, 8
  s_sub_u32 s33, s33, s50
  s_mov_b32 s39, 28
  s_mov_b32 s36, 3072
  s_and_b32 s41, s2, 15
  s_lshr_b32 s42, s2, 4
  s_mul_i32 s35, s41, 28
  s_add_u32 s35, s35, s34
  s_mul_i32 s35, s35, 3
  s_add_u32 s35, s35, s42
  s_lshl_b32 s35, s35, 10
  s_add_u32 s35, s35, 8388608
prep_go:
  v_bfe_u32 v5, v0, 2, 4
  v_mul_lo_u32 v5, v5, s32
  v_and_b32 v6, 3, v0
  v_lshl_add_u32 v5, v6, 4, v5
  v_add_u32 v5, s33, v5
  s_lshl_b32 s47, s20, 13
  v_add_u32 v7, s47, v4
  s_add_u32 s41, s34, 0
  s_lshl_b32 s42, s41, 4
  s_lshr_b32 s43, s41, 1
  s_lshl_b32 s43, s43, 2
  s_mul_i32 s43, s43, s40
  s_sub_u32 s42, s42, s43
  s_mul_i32 s42, s42, s32
  buffer_load_dwordx4 v[80:83], v5, s[28:31], s42 offen
  s_add_u32 s41, s34, 1
  s_lshl_b32 s42, s41, 4
  s_lshr_b32 s43, s41, 1
  s_lshl_b32 s43, s43, 2
  s_mul_i32 s43, s43, s40
  s_sub_u32 s42, s42, s43
  s_mul_i32 s42, s42, s32
  buffer_load_dwordx4 v[84:87], v5, s[28:31], s42 offen
  s_add_u32 s41, s34, 2
  s_lshl_b32 s42, s41, 4
  s_lshr_b32 s43, s41, 1
  s_lshl_b32 s43, s43, 2
  s_mul_i32 s43, s43, s40
  s_sub_u32 s42, s42, s43
  s_mul_i32 s42, s42, s32
  buffer_load_dwordx4 v[88:91], v5, s[28:31], s42 offen
  s_add_u32 s41, s34, 3
  s_lshl_b32 s42, s41, 4
  s_lshr_b32 s43, s41, 1
  s_lshl_b32 s43, s43, 2
  s_mul_i32 s43, s43, s40
  s_sub_u32 s42, s42, s43
  s_mul_i32 s42, s42, s32
  buffer_load_dwordx4 v[92:95], v5, s[28:31], s42 offen
  s_add_u32 s41, s34, 4
  s_lshl_b32 s42, s41, 4
  s_lshr_b32 s43, s41, 1
  s_lshl_b32 s43, s43, 2
  s_mul_i32 s43, s43, s40
  s_sub_u32 s42, s42, s43
  s_mul_i32 s42, s42, s32
  buffer_load_dwordx4 v[96:99], v5, s[28:31], s42 offen
  s_add_u32 s41, s34, 5
  s_lshl_b32 s42, s41, 4
  s_lshr_b32 s43, s41, 1
  s_lshl_b32 s43, s43, 2
  s_mul_i32 s43, s43, s40
  s_sub_u32 s42, s42, s43
  s_mul_i32 s42, s42, s32
  buffer_load_dwordx4 v[100:103], v5, s[28:31], s42 offen
  s_add_u32 s41, s34, 6
  s_lshl_b32 s42, s41, 4
  s_lshr_b32 s43, s41, 1
  s_lshl_b32 s43, s43, 2
  s_mul_i32 s43, s43, s40
  s_sub_u32 s42, s42, s43
  s_mul_i32 s42, s42, s32
  buffer_load_dwordx4 v[104:107], v5, s[28:31], s42 offen
  s_cmp_lt_u32 s38, 8
  s_cbranch_scc1 prep_ld_done
  s_add_u32 s41, s34, 7
  s_lshl_b32 s42, s41, 4
  s_lshr_b32 s43, s41, 1
  s_lshl_b32 s43, s43, 2
  s_mul_i32 s43, s43, s40
  s_sub_u32 s42, s42, s43
  s_mul_i32 s42, s42, s32
  buffer_load_dwordx4 v[108:111], v5, s[28:31], s42 offen
prep_ld_done:
  v_bfe_u32 v8, v0, 2, 2
  v_lshl_add_u32 v8, v3, 2, v8
  v_lshlrev_b32 v8, 6, v8
  v_bfe_u32 v9, v0, 4, 1
  v_lshl_add_u32 v8, v9, 5, v8
  v_lshl_add_u32 v8, v6, 3, v8
  s_add_u32 s50, s50, s47
  v_add_u32 v8, s50, v8
  v_cmp_gt_u32 s[48:49], s39, v2
  v_cmp_ne_u32 vcc, 0, v3
  s_cmp_eq_u32 s40, 1
  s_cselect_b64 s[44:45], vcc, 0
  v_mov_b32 v9, 0
  s_waitcnt vmcnt(0)
  s_cmp_ge_u32 s58, 14
  s_cbranch_scc1 prep_nx2b
  s_mov_b32 s46, 0x3f803f80
  v_mov_b32 v152, 0
  v_mov_b32 v153, 0
  v_lshrrev_b32 v154, 2, v4
  buffer_store_dwordx4 v[144:147], v4, s[24:27], s59 offen offset:0 sc1
  v_dot2_f32_bf16 v152, v144, s46, v152
  v_dot2_f32_bf16 v153, v144, v144, v153
  v_dot2_f32_bf16 v152, v145, s46, v152
  v_dot2_f32_bf16 v153, v145, v145, v153
  v_dot2_f32_bf16 v152, v146, s46, v152
  v_dot2_f32_bf16 v153, v146, v146, v153
  v_dot2_f32_bf16 v152, v147, s46, v152
  v_dot2_f32_bf16 v153, v147, v147, v153
  buffer_store_dwordx4 v[148:151], v4, s[24:27], s59 offen offset:1024 sc1
  v_dot2_f32_bf16 v152, v148, s46, v152
  v_dot2_f32_bf16 v153, v148, v148, v153
  v_dot2_f32_bf16 v152, v149, s46, v152
  v_dot2_f32_bf16 v153, v149, v149, v153
  v_dot2_f32_bf16 v152, v150, s46, v152
  v_dot2_f32_bf16 v153, v150, v150, v153
  v_dot2_f32_bf16 v152, v151, s46, v152
  v_dot2_f32_bf16 v153, v151, v151, v153
  s_nop 4
  v_permlane32_swap_b32 v152, v153
  s_nop 1
  v_add_f32 v152, v152, v153
  buffer_store_dword v152, v154, s[24:27], s60 offen sc1
prep_nx2b:
  buffer_load_dword v155, v1, s[52:55], 0 offen sc1
  ds_write_b128 v7, v[80:83] offset:0
  ds_write_b128 v7, v[84:87] offset:1024
  ds_write_b128 v7, v[88:91] offset:2048
  ds_write_b128 v7, v[92:95] offset:3072
  ds_write_b128 v7, v[96:99] offset:4096
  ds_write_b128 v7, v[100:103] offset:5120
  ds_write_b128 v7, v[104:107] offset:6144
  ds_write_b128 v7, v[108:111] offset:7168
  ds_read_b64_tr_b16 v[112:113], v8 offset:0
  ds_read_b64_tr_b16 v[114:115], v8 offset:512
  ds_read_b64_tr_b16 v[116:117], v8 offset:1024
  ds_read_b64_tr_b16 v[118:119], v8 offset:1536
  ds_read_b64_tr_b16 v[120:121], v8 offset:2048
  ds_read_b64_tr_b16 v[122:123], v8 offset:2560
  ds_read_b64_tr_b16 v[124:125], v8 offset:3072
  ds_read_b64_tr_b16 v[126:127], v8 offset:3584
  ds_read_b64_tr_b16 v[128:129], v8 offset:4096
  ds_read_b64_tr_b16 v[130:131], v8 offset:4608
  ds_read_b64_tr_b16 v[132:133], v8 offset:5120
  ds_read_b64_tr_b16 v[134:135], v8 offset:5632
  ds_read_b64_tr_b16 v[136:137], v8 offset:6144
  ds_read_b64_tr_b16 v[138:139], v8 offset:6656
  ds_read_b64_tr_b16 v[140:141], v8 offset:7168
  ds_read_b64_tr_b16 v[142:143], v8 offset:7680
  s_waitcnt lgkmcnt(0)
  v_cndmask_b32 v118, v118, v9, s[44:45]
  v_cndmask_b32 v119, v119, v9, s[44:45]
  v_cndmask_b32 v126, v126, v9, s[44:45]
  v_cndmask_b32 v127, v127, v9, s[44:45]
  v_cndmask_b32 v134, v134, v9, s[44:45]
  v_cndmask_b32 v135, v135, v9, s[44:45]
  v_cndmask_b32 v142, v142, v9, s[44:45]
  v_cndmask_b32 v143, v143, v9, s[44:45]
  s_cmp_eq_u32 s37, 0
  s_cbranch_scc1 prep_nocenter
  s_mov_b32 s46, 0x3f803f80
  v_mov_b32 v10, 0
  v_mov_b32 v11, 0
  v_mov_b32 v12, 0
  v_mov_b32 v13, 0
  v_cndmask_b32 v112, v9, v112, s[48:49]
  v_cndmask_b32 v113, v9, v113, s[48:49]
  v_cndmask_b32 v114, v9, v114, s[48:49]
  v_cndmask_b32 v115, v9, v115, s[48:49]
  v_cndmask_b32 v116, v9, v116, s[48:49]
  v_cndmask_b32 v117, v9, v117, s[48:49]
  v_cndmask_b32 v118, v9, v118, s[48:49]
  v_cndmask_b32 v119, v9, v119, s[48:49]
  v_cndmask_b32 v120, v9, v120, s[48:49]
  v_cndmask_b32 v121, v9, v121, s[48:49]
  v_cndmask_b32 v122, v9, v122, s[48:49]
  v_cndmask_b32 v123, v9, v123, s[48:49]
  v_cndmask_b32 v124, v9, v124, s[48:49]
  v_cndmask_b32 v125, v9, v125, s[48:49]
  v_cndmask_b32 v126, v9, v126, s[48:49]
  v_cndmask_b32 v127, v9, v127, s[48:49]
  v_cndmask_b32 v128, v9, v128, s[48:49]
  v_cndmask_b32 v129, v9, v129, s[48:49]
  v_cndmask_b32 v130, v9, v130, s[48:49]
  v_cndmask_b32 v131, v9, v131, s[48:49]
  v_cndmask_b32 v132, v9, v132, s[48:49]
  v_cndmask_b32 v133, v9, v133, s[48:49]
  v_cndmask_b32 v134, v9, v134, s[48:49]
  v_cndmask_b32 v135, v9, v135, s[48:49]
  v_cndmask_b32 v136, v9, v136, s[48:49]
  v_cndmask_b32 v137, v9, v137, s[48:49]
  v_cndmask_b32 v138, v9, v138, s[48:49]
  v_cndmask_b32 v139, v9, v139, s[48:49]
  v_dot2_f32_bf16 v10, v112, s46, v10
  v_dot2_f32_bf16 v11, v113, s46, v11
  v_dot2_f32_bf16 v12, v114, s46, v12
  v_dot2_f32_bf16 v13, v115, s46, v13
  v_dot2_f32_bf16 v10, v116, s46, v10
  v_dot2_f32_bf16 v11, v117, s46, v11
  v_dot2_f32_bf16 v12, v118, s46, v12
  v_dot2_f32_bf16 v13, v119, s46, v13
  v_dot2_f32_bf16 v10, v120, s46, v10
  v_dot2_f32_bf16 v11, v121, s46, v11
  v_dot2_f32_bf16 v12, v122, s46, v12
  v_dot2_f32_bf16 v13, v123, s46, v13
  v_dot2_f32_bf16 v10, v124, s46, v10
  v_dot2_f32_bf16 v11, v125, s46, v11
  v_dot2_f32_bf16 v12, v126, s46, v12
  v_dot2_f32_bf16 v13, v127, s46, v13
  v_dot2_f32_bf16 v10, v128, s46, v10
  v_dot2_f32_bf16 v11, v129, s46, v11
  v_dot2_f32_bf16 v12, v130, s46, v12
  v_dot2_f32_bf16 v13, v131, s46, v13
  v_dot2_f32_bf16 v10, v132, s46, v10
  v_dot2_f32_bf16 v11, v133, s46, v11
  v_dot2_f32_bf16 v12, v134, s46, v12
  v_dot2_f32_bf16 v13, v135, s46, v13
  v_dot2_f32_bf16 v10, v136, s46, v10
  v_dot2_f32_bf16 v11, v137, s46, v11
  v_dot2_f32_bf16 v12, v138, s46, v12
  v_dot2_f32_bf16 v13, v139, s46, v13
  v_lshlrev_b32 v14, 2, v0
  s_nop 2
  v_add_f32 v10, v10, v11
  v_add_f32 v12, v12, v13
  v_add_f32 v10, v10, v12
  ds_write_b32 v14, v10 offset:32768
  v_lshlrev_b32 v16, 16, v112
  v_and_b32 v17, 0xffff0000, v112
  v_lshlrev_b32 v18, 16, v113
  v_and_b32 v19, 0xffff0000, v113
  v_lshlrev_b32 v20, 16, v114
  v_and_b32 v21, 0xffff0000, v114
  v_lshlrev_b32 v22, 16, v115
  v_and_b32 v23, 0xffff0000, v115
  v_lshlrev_b32 v24, 16, v116
  v_and_b32 v25, 0xffff0000, v116
  v_lshlrev_b32 v26, 16, v117
  v_and_b32 v27, 0xffff0000, v117
  v_lshlrev_b32 v28, 16, v118
  v_and_b32 v29, 0xffff0000, v118
  v_lshlrev_b32 v30, 16, v119
  v_and_b32 v31, 0xffff0000, v119
  v_lshlrev_b32 v32, 16, v120
  v_and_b32 v33, 0xffff0000, v120
  v_lshlrev_b32 v34, 16, v121
  v_and_b32 v35, 0xffff0000, v121
  v_lshlrev_b32 v36, 16, v122
  v_and_b32 v37, 0xffff0000, v122
  v_lshlrev_b32 v38, 16, v123
  v_and_b32 v39, 0xffff0000, v123
  v_lshlrev_b32 v40, 16, v124
  v_and_b32 v41, 0xffff0000, v124
  v_lshlrev_b32 v42, 16, v125
  v_and_b32 v43, 0xffff0000, v125
  v_lshlrev_b32 v11, 2, v2
  s_waitcnt lgkmcnt(0)
  s_barrier
  ds_read_b32 v80, v11 offset:32768
  ds_read_b32 v81, v11 offset:32896
  ds_read_b32 v82, v11 offset:33024
  ds_read_b32 v83, v11 offset:33152
  ds_read_b32 v84, v11 offset:33280
  ds_read_b32 v85, v11 offset:33408
  ds_read_b32 v86, v11 offset:33536
  ds_read_b32 v87, v11 offset:33664
  v_lshlrev_b32 v44, 16, v126
  v_and_b32 v45, 0xffff0000, v126
  v_lshlrev_b32 v46, 16, v127
  v_and_b32 v47, 0xffff0000, v127
  v_lshlrev_b32 v48, 16, v128
  v_and_b32 v49, 0xffff0000, v128
  v_lshlrev_b32 v50, 16, v129
  v_and_b32 v51, 0xffff0000, v129
  v_lshlrev_b32 v52, 16, v130
  v_and_b32 v53, 0xffff0000, v130
  v_lshlrev_b32 v54, 16, v131
  v_and_b32 v55, 0xffff0000, v131
  v_lshlrev_b32 v56, 16, v132
  v_and_b32 v57, 0xffff0000, v132
  v_lshlrev_b32 v58, 16, v133
  v_and_b32 v59, 0xffff0000, v133
  v_lshlrev_b32 v60, 16, v134
  v_and_b32 v61, 0xffff0000, v134
  v_lshlrev_b32 v62, 16, v135
  v_and_b32 v63, 0xffff0000, v135
  v_lshlrev_b32 v64, 16, v136
  v_and_b32 v65, 0xffff0000, v136
  v_lshlrev_b32 v66, 16, v137
  v_and_b32 v67, 0xffff0000, v137
  v_lshlrev_b32 v68, 16, v138
  v_and_b32 v69, 0xffff0000, v138
  v_lshlrev_b32 v70, 16, v139
  v_and_b32 v71, 0xffff0000, v139
  s_waitcnt lgkmcnt(0)
  v_add_f32 v80, v80, v81
  v_add_f32 v82, v82, v83
  v_add_f32 v84, v84, v85
  v_add_f32 v86, v86, v87
  v_add_f32 v80, v80, v82
  v_add_f32 v84, v84, v86
  v_add_f32 v80, v80, v84
  v_mul_f32 v81, 0xbb124925, v80
  v_mul_f32 v80, 0xbb124925, v80
  v_pk_add_f32 v[16:17], v[16:17], v[80:81]
  v_pk_add_f32 v[18:19], v[18:19], v[80:81]
  v_pk_add_f32 v[20:21], v[20:21], v[80:81]
  v_pk_add_f32 v[22:23], v[22:23], v[80:81]
  v_pk_add_f32 v[24:25], v[24:25], v[80:81]
  v_pk_add_f32 v[26:27], v[26:27], v[80:81]
  v_pk_add_f32 v[28:29], v[28:29], v[80:81]
  v_pk_add_f32 v[30:31], v[30:31], v[80:81]
  v_pk_add_f32 v[32:33], v[32:33], v[80:81]
  v_pk_add_f32 v[34:35], v[34:35], v[80:81]
  v_pk_add_f32 v[36:37], v[36:37], v[80:81]
  v_pk_add_f32 v[38:39], v[38:39], v[80:81]
  v_pk_add_f32 v[40:41], v[40:41], v[80:81]
  v_pk_add_f32 v[42:43], v[42:43], v[80:81]
  v_pk_add_f32 v[44:45], v[44:45], v[80:81]
  v_pk_add_f32 v[46:47], v[46:47], v[80:81]
  v_pk_add_f32 v[48:49], v[48:49], v[80:81]
  v_pk_add_f32 v[50:51], v[50:51], v[80:81]
  v_pk_add_f32 v[52:53], v[52:53], v[80:81]
  v_pk_add_f32 v[54:55], v[54:55], v[80:81]
  v_pk_add_f32 v[56:57], v[56:57], v[80:81]
  v_pk_add_f32 v[58:59], v[58:59], v[80:81]
  v_pk_add_f32 v[60:61], v[60:61], v[80:81]
  v_pk_add_f32 v[62:63], v[62:63], v[80:81]
  v_pk_add_f32 v[64:65], v[64:65], v[80:81]
  v_pk_add_f32 v[66:67], v[66:67], v[80:81]
  v_pk_add_f32 v[68:69], v[68:69], v[80:81]
  v_pk_add_f32 v[70:71], v[70:71], v[80:81]
  v_mov_b32 v104, 0
  v_cvt_pk_bf16_f32 v112, v16, v16
  v_cvt_pk_bf16_f32 v116, v24, v24
  v_cvt_pk_bf16_f32 v120, v32, v32
  v_cvt_pk_bf16_f32 v124, v40, v40
  v_cvt_pk_bf16_f32 v128, v48, v48
  v_cvt_pk_bf16_f32 v132, v56, v56
  v_cvt_pk_bf16_f32 v136, v64, v64
  v_and_b32 v96, 0xffff0000, v112
  v_and_b32 v97, 0xffff0000, v116
  v_and_b32 v98, 0xffff0000, v120
  v_and_b32 v99, 0xffff0000, v124
  v_and_b32 v100, 0xffff0000, v128
  v_and_b32 v101, 0xffff0000, v132
  v_and_b32 v102, 0xffff0000, v136
  v_sub_f32 v96, v16, v96
  v_sub_f32 v97, v24, v97
  v_sub_f32 v98, v32, v98
  v_sub_f32 v99, v40, v99
  v_sub_f32 v100, v48, v100
  v_sub_f32 v101, v56, v101
  v_sub_f32 v102, v64, v102
  v_add_f32 v17, v17, v96
  v_add_f32 v25, v25, v97
  v_add_f32 v33, v33, v98
  v_add_f32 v41, v41, v99
  v_add_f32 v49, v49, v100
  v_add_f32 v57, v57, v101
  v_add_f32 v65, v65, v102
  v_cvt_pk_bf16_f32 v112, v16, v17
  v_cvt_pk_bf16_f32 v116, v24, v25
  v_cvt_pk_bf16_f32 v120, v32, v33
  v_cvt_pk_bf16_f32 v124, v40, v41
  v_cvt_pk_bf16_f32 v128, v48, v49
  v_cvt_pk_bf16_f32 v132, v56, v57
  v_cvt_pk_bf16_f32 v136, v64, v65
  v_and_b32 v88, 0xffff0000, v112
  v_and_b32 v89, 0xffff0000, v116
  v_and_b32 v90, 0xffff0000, v120
  v_and_b32 v91, 0xffff0000, v124
  v_and_b32 v92, 0xffff0000, v128
  v_and_b32 v93, 0xffff0000, v132
  v_and_b32 v94, 0xffff0000, v136
  v_sub_f32 v88, v17, v88
  v_sub_f32 v89, v25, v89
  v_sub_f32 v90, v33, v90
  v_sub_f32 v91, v41, v91
  v_sub_f32 v92, v49, v92
  v_sub_f32 v93, v57, v93
  v_sub_f32 v94, v65, v94
  v_add_f32 v18, v18, v88
  v_add_f32 v26, v26, v89
  v_add_f32 v34, v34, v90
  v_add_f32 v42, v42, v91
  v_add_f32 v50, v50, v92
  v_add_f32 v58, v58, v93
  v_add_f32 v66, v66, v94
  v_cvt_pk_bf16_f32 v113, v18, v18
  v_cvt_pk_bf16_f32 v117, v26, v26
  v_cvt_pk_bf16_f32 v121, v34, v34
  v_cvt_pk_bf16_f32 v125, v42, v42
  v_cvt_pk_bf16_f32 v129, v50, v50
  v_cvt_pk_bf16_f32 v133, v58, v58
  v_cvt_pk_bf16_f32 v137, v66, v66
  v_and_b32 v96, 0xffff0000, v113
  v_and_b32 v97, 0xffff0000, v117
  v_and_b32 v98, 0xffff0000, v121
  v_and_b32 v99, 0xffff0000, v125
  v_and_b32 v100, 0xffff0000, v129
  v_and_b32 v101, 0xffff0000, v133
  v_and_b32 v102, 0xffff0000, v137
  v_sub_f32 v96, v18, v96
  v_sub_f32 v97, v26, v97
  v_sub_f32 v98, v34, v98
  v_sub_f32 v99, v42, v99
  v_sub_f32 v100, v50, v100
  v_sub_f32 v101, v58, v101
  v_sub_f32 v102, v66, v102
  v_add_f32 v19, v19, v96
  v_add_f32 v27, v27, v97
  v_add_f32 v35, v35, v98
  v_add_f32 v43, v43, v99
  v_add_f32 v51, v51, v100
  v_add_f32 v59, v59, v101
  v_add_f32 v67, v67, v102
  v_cvt_pk_bf16_f32 v113, v18, v19
  v_cvt_pk_bf16_f32 v117, v26, v27
  v_cvt_pk_bf16_f32 v121, v34, v35
  v_cvt_pk_bf16_f32 v125, v42, v43
  v_cvt_pk_bf16_f32 v129, v50, v51
  v_cvt_pk_bf16_f32 v133, v58, v59
  v_cvt_pk_bf16_f32 v137, v66, v67
  v_and_b32 v88, 0xffff0000, v113
  v_and_b32 v89, 0xffff0000, v117
  v_and_b32 v90, 0xffff0000, v121
  v_and_b32 v91, 0xffff0000, v125
  v_and_b32 v92, 0xffff0000, v129
  v_and_b32 v93, 0xffff0000, v133
  v_and_b32 v94, 0xffff0000, v137
  v_sub_f32 v88, v19, v88
  v_sub_f32 v89, v27, v89
  v_sub_f32 v90, v35, v90
  v_sub_f32 v91, v43, v91
  v_sub_f32 v92, v51, v92
  v_sub_f32 v93, v59, v93
  v_sub_f32 v94, v67, v94
  v_add_f32 v20, v20, v88
  v_add_f32 v28, v28, v89
  v_add_f32 v36, v36, v90
  v_add_f32 v44, v44, v91
  v_add_f32 v52, v52, v92
  v_add_f32 v60, v60, v93
  v_add_f32 v68, v68, v94
  v_cvt_pk_bf16_f32 v114, v20, v20
  v_cvt_pk_bf16_f32 v118, v28, v28
  v_cvt_pk_bf16_f32 v122, v36, v36
  v_cvt_pk_bf16_f32 v126, v44, v44
  v_cvt_pk_bf16_f32 v130, v52, v52
  v_cvt_pk_bf16_f32 v134, v60, v60
  v_cvt_pk_bf16_f32 v138, v68, v68
  v_and_b32 v96, 0xffff0000, v114
  v_and_b32 v97, 0xffff0000, v118
  v_and_b32 v98, 0xffff0000, v122
  v_and_b32 v99, 0xffff0000, v126
  v_and_b32 v100, 0xffff0000, v130
  v_and_b32 v101, 0xffff0000, v134
  v_and_b32 v102, 0xffff0000, v138
  v_sub_f32 v96, v20, v96
  v_sub_f32 v97, v28, v97
  v_sub_f32 v98, v36, v98
  v_sub_f32 v99, v44, v99
  v_sub_f32 v100, v52, v100
  v_sub_f32 v101, v60, v101
  v_sub_f32 v102, v68, v102
  v_add_f32 v21, v21, v96
  v_add_f32 v29, v29, v97
  v_add_f32 v37, v37, v98
  v_add_f32 v45, v45, v99
  v_add_f32 v53, v53, v100
  v_add_f32 v61, v61, v101
  v_add_f32 v69, v69, v102
  v_cvt_pk_bf16_f32 v114, v20, v21
  v_cvt_pk_bf16_f32 v118, v28, v29
  v_cvt_pk_bf16_f32 v122, v36, v37
  v_cvt_pk_bf16_f32 v126, v44, v45
  v_cvt_pk_bf16_f32 v130, v52, v53
  v_cvt_pk_bf16_f32 v134, v60, v61
  v_cvt_pk_bf16_f32 v138, v68, v69
  v_and_b32 v88, 0xffff0000, v114
  v_and_b32 v89, 0xffff0000, v118
  v_and_b32 v90, 0xffff0000, v122
  v_and_b32 v91, 0xffff0000, v126
  v_and_b32 v92, 0xffff0000, v130
  v_and_b32 v93, 0xffff0000, v134
  v_and_b32 v94, 0xffff0000, v138
  v_sub_f32 v88, v21, v88
  v_sub_f32 v89, v29, v89
  v_sub_f32 v90, v37, v90
  v_sub_f32 v91, v45, v91
  v_sub_f32 v92, v53, v92
  v_sub_f32 v93, v61, v93
  v_sub_f32 v94, v69, v94
  v_add_f32 v22, v22, v88
  v_add_f32 v30, v30, v89
  v_add_f32 v38, v38, v90
  v_add_f32 v46, v46, v91
  v_add_f32 v54, v54, v92
  v_add_f32 v62, v62, v93
  v_add_f32 v70, v70, v94
  v_cvt_pk_bf16_f32 v115, v22, v22
  v_cvt_pk_bf16_f32 v119, v30, v30
  v_cvt_pk_bf16_f32 v123, v38, v38
  v_cvt_pk_bf16_f32 v127, v46, v46
  v_cvt_pk_bf16_f32 v131, v54, v54
  v_cvt_pk_bf16_f32 v135, v62, v62
  v_cvt_pk_bf16_f32 v139, v70, v70
  v_and_b32 v96, 0xffff0000, v115
  v_and_b32 v97, 0xffff0000, v119
  v_and_b32 v98, 0xffff0000, v123
  v_and_b32 v99, 0xffff0000, v127
  v_and_b32 v100, 0xffff0000, v131
  v_and_b32 v101, 0xffff0000, v135
  v_and_b32 v102, 0xffff0000, v139
  v_sub_f32 v96, v22, v96
  v_sub_f32 v97, v30, v97
  v_sub_f32 v98, v38, v98
  v_sub_f32 v99, v46, v99
  v_sub_f32 v100, v54, v100
  v_sub_f32 v101, v62, v101
  v_sub_f32 v102, v70, v102
  v_add_f32 v23, v23, v96
  v_add_f32 v31, v31, v97
  v_add_f32 v39, v39, v98
  v_add_f32 v47, v47, v99
  v_add_f32 v55, v55, v100
  v_add_f32 v63, v63, v101
  v_add_f32 v71, v71, v102
  v_cvt_pk_bf16_f32 v115, v22, v23
  v_cvt_pk_bf16_f32 v119, v30, v31
  v_cvt_pk_bf16_f32 v123, v38, v39
  v_cvt_pk_bf16_f32 v127, v46, v47
  v_cvt_pk_bf16_f32 v131, v54, v55
  v_cvt_pk_bf16_f32 v135, v62, v63
  v_and_b32 v88, 0xffff0000, v115
  v_and_b32 v89, 0xffff0000, v119
  v_and_b32 v90, 0xffff0000, v123
  v_and_b32 v91, 0xffff0000, v127
  v_and_b32 v92, 0xffff0000, v131
  v_and_b32 v93, 0xffff0000, v135
  v_sub_f32 v88, v23, v88
  v_sub_f32 v89, v31, v89
  v_sub_f32 v90, v39, v90
  v_sub_f32 v91, v47, v91
  v_sub_f32 v92, v55, v92
  v_sub_f32 v93, v63, v93
  v_add_f32 v88, v88, v89
  v_add_f32 v90, v90, v91
  v_add_f32 v92, v92, v93
  v_add_f32 v88, v88, v90
  v_add_f32 v71, v71, v92
  v_add_f32 v71, v71, v88
  v_cvt_pk_bf16_f32 v139, v70, v71
  v_and_b32 v88, 0xffff0000, v139
  v_sub_f32 v88, v71, v88
  s_nop 1
  v_permlane32_swap_b32 v104, v88
  s_nop 1
  v_add_f32 v71, v71, v104
  v_cvt_pk_bf16_f32 v139, v70, v71
prep_nocenter:
  s_mov_b32 s5, 0x8000
  s_branch prep_flcb
prep_flb:
  buffer_load_dword v155, v1, s[52:55], 0 offen sc1
prep_flcb:
  s_waitcnt vmcnt(0)
  v_readfirstlane_b32 s6, v155
  s_sub_u32 s5, s5, 1
  s_cbranch_scc1 prep_fldb
  s_cmp_eq_u32 s6, 0
  s_cbranch_scc1 prep_flb
prep_fldb:
  v_mov_b32 v152, 1
  s_barrier
  s_cmp_eq_u32 s20, 0
  s_cbranch_scc0 prep_sgb
  s_lshl_b32 s4, s21, 8
  s_add_u32 s4, s4, 39886848
  s_mov_b64 exec, 1
  buffer_atomic_add v152, v1, s[24:27], s4 offen sc1
  s_mov_b64 exec, -1
prep_sgb:
  buffer_store_dwordx4 v[112:115], v4, s[24:27], s35 offen sc1
  s_add_u32 s35, s35, s36
  buffer_store_dwordx4 v[116:119], v4, s[24:27], s35 offen sc1
  s_add_u32 s35, s35, s36
  buffer_store_dwordx4 v[120:123], v4, s[24:27], s35 offen sc1
  s_add_u32 s35, s35, s36
  buffer_store_dwordx4 v[124:127], v4, s[24:27], s35 offen sc1
  s_add_u32 s35, s35, s36
  buffer_store_dwordx4 v[128:131], v4, s[24:27], s35 offen sc1
  s_add_u32 s35, s35, s36
  buffer_store_dwordx4 v[132:135], v4, s[24:27], s35 offen sc1
  s_add_u32 s35, s35, s36
  buffer_store_dwordx4 v[136:139], v4, s[24:27], s35 offen sc1
  s_add_u32 s35, s35, s36
  s_cmp_lt_u32 s38, 8
  s_cbranch_scc1 prep_fin
  buffer_store_dwordx4 v[140:143], v4, s[24:27], s35 offen sc1
  s_add_u32 s35, s35, s36
prep_fin:
  s_cmp_lt_u32 s2, 48
  s_cbranch_scc0 prep_done
  s_waitcnt vmcnt(0)
  s_barrier
  s_cmp_eq_u32 s20, 0
  s_cbranch_scc0 prep_done
  s_and_b32 s5, s2, 15
  s_lshl_b32 s5, s5, 8
  s_add_u32 s5, s5, 39890944
  s_mov_b64 exec, 1
  buffer_atomic_add v152, v1, s[24:27], s5 offen sc1
  s_mov_b64 exec, -1
  s_branch prep_done
prep_t1:
  s_cmp_ge_u32 s2, 160
  s_cbranch_scc1 prep_t2
  s_sub_u32 s41, s2, 48
  s_and_b32 s42, s41, 1
  s_lshr_b32 s41, s41, 1
  s_cmp_eq_u32 s42, 0
  s_cselect_b32 s28, s12, s14
  s_cselect_b32 s29, s13, s15
  s_and_b32 s29, s29, 0xffff
  s_mov_b32 s30, 1605632
  s_mov_b32 s32, 3584
  s_lshl_b32 s33, s41, 6
  s_mov_b32 s36, 2048
  s_mul_i32 s35, s41, 28
  s_add_u32 s35, s35, s34
  s_lshl_b32 s35, s35, 1
  s_add_u32 s35, s35, s42
  s_lshl_b32 s35, s35, 10
  s_add_u32 s35, s35, 12582912
  s_branch prep_go
prep_t2:
  s_mov_b32 s37, 0
  s_mov_b32 s32, 896
  s_cmp_ge_u32 s2, 174
  s_cbranch_scc1 prep_t3
  s_sub_u32 s41, s2, 160
  s_mov_b32 s28, s8
  s_and_b32 s29, s9, 0xffff
  s_mov_b32 s30, 401408
  s_lshl_b32 s33, s41, 6
  s_mov_b32 s38, 8
  s_mov_b32 s40, 1
  s_lshl_b32 s34, s20, 3
  s_lshl_b32 s35, s41, 5
  s_add_u32 s35, s35, s34
  s_lshl_b32 s35, s35, 10
  s_add_u32 s35, s35, 10485760
  s_branch prep_go
prep_t3:
  s_sub_u32 s41, s2, 174
  s_and_b32 s42, s41, 3
  s_lshr_b32 s41, s41, 2
  s_mov_b32 s28, s16
  s_and_b32 s29, s17, 0xffff
  s_mov_b32 s30, 1605632
  s_lshl_b32 s33, s41, 6
  s_mul_i32 s42, s42, 28
  s_add_u32 s34, s34, s42
  s_mul_i32 s35, s41, 112
  s_add_u32 s35, s35, s34
  s_lshl_b32 s35, s35, 10
  s_add_u32 s35, s35, 16777216
  s_branch prep_go
prep_idle:
  s_cmp_eq_u32 s2, 255
  s_cbranch_scc0 prep_nz
  v_mov_b32 v8, 0
  v_mov_b32 v9, 0
  v_mov_b32 v10, 0
  v_mov_b32 v11, 0
  v_lshlrev_b32 v12, 4, v0
  s_mov_b32 s41, 39845888
  buffer_store_dwordx4 v[8:11], v12, s[24:27], s41 offen sc1
  s_add_u32 s41, s41, 4096
  buffer_store_dwordx4 v[8:11], v12, s[24:27], s41 offen sc1
  s_add_u32 s41, s41, 4096
  buffer_store_dwordx4 v[8:11], v12, s[24:27], s41 offen sc1
  s_add_u32 s41, s41, 4096
  buffer_store_dwordx4 v[8:11], v12, s[24:27], s41 offen sc1
  s_add_u32 s41, s41, 4096
  buffer_store_dwordx4 v[8:11], v12, s[24:27], s41 offen sc1
  s_add_u32 s41, s41, 4096
  buffer_store_dwordx4 v[8:11], v12, s[24:27], s41 offen sc1
  s_add_u32 s41, s41, 4096
  buffer_store_dwordx4 v[8:11], v12, s[24:27], s41 offen sc1
  s_add_u32 s41, s41, 4096
  buffer_store_dwordx4 v[8:11], v12, s[24:27], s41 offen sc1
  s_add_u32 s41, s41, 4096
  buffer_store_dwordx4 v[8:11], v12, s[24:27], s41 offen sc1
  s_add_u32 s41, s41, 4096
  buffer_store_dwordx4 v[8:11], v12, s[24:27], s41 offen sc1
  s_add_u32 s41, s41, 4096
  buffer_store_dwordx4 v[8:11], v12, s[24:27], s41 offen sc1
  s_add_u32 s41, s41, 4096
  buffer_store_dwordx4 v[8:11], v12, s[24:27], s41 offen sc1
  s_add_u32 s41, s41, 4096
  s_waitcnt vmcnt(0)
  s_barrier
  v_mov_b32 v9, 1
  buffer_store_dword v9, v8, s[52:55], 0 offen sc1
prep_nz:
  s_waitcnt vmcnt(0)
  s_cmp_ge_u32 s58, 14
  s_cbranch_scc1 prep_nx2a
  s_mov_b32 s46, 0x3f803f80
  v_mov_b32 v152, 0
  v_mov_b32 v153, 0
  v_lshrrev_b32 v154, 2, v4
  buffer_store_dwordx4 v[144:147], v4, s[24:27], s59 offen offset:0 sc1
  v_dot2_f32_bf16 v152, v144, s46, v152
  v_dot2_f32_bf16 v153, v144, v144, v153
  v_dot2_f32_bf16 v152, v145, s46, v152
  v_dot2_f32_bf16 v153, v145, v145, v153
  v_dot2_f32_bf16 v152, v146, s46, v152
  v_dot2_f32_bf16 v153, v146, v146, v153
  v_dot2_f32_bf16 v152, v147, s46, v152
  v_dot2_f32_bf16 v153, v147, v147, v153
  buffer_store_dwordx4 v[148:151], v4, s[24:27], s59 offen offset:1024 sc1
  v_dot2_f32_bf16 v152, v148, s46, v152
  v_dot2_f32_bf16 v153, v148, v148, v153
  v_dot2_f32_bf16 v152, v149, s46, v152
  v_dot2_f32_bf16 v153, v149, v149, v153
  v_dot2_f32_bf16 v152, v150, s46, v152
  v_dot2_f32_bf16 v153, v150, v150, v153
  v_dot2_f32_bf16 v152, v151, s46, v152
  v_dot2_f32_bf16 v153, v151, v151, v153
  s_nop 4
  v_permlane32_swap_b32 v152, v153
  s_nop 1
  v_add_f32 v152, v152, v153
  buffer_store_dword v152, v154, s[24:27], s60 offen sc1
prep_nx2a:
  buffer_load_dword v155, v1, s[52:55], 0 offen sc1
  s_mov_b32 s5, 0x8000
  s_branch prep_flca
prep_fla:
  buffer_load_dword v155, v1, s[52:55], 0 offen sc1
prep_flca:
  s_waitcnt vmcnt(0)
  v_readfirstlane_b32 s6, v155
  s_sub_u32 s5, s5, 1
  s_cbranch_scc1 prep_flda
  s_cmp_eq_u32 s6, 0
  s_cbranch_scc1 prep_fla
prep_flda:
  v_mov_b32 v152, 1
  s_barrier
  s_cmp_eq_u32 s20, 0
  s_cbranch_scc0 prep_sga
  s_lshl_b32 s4, s21, 8
  s_add_u32 s4, s4, 39886848
  s_mov_b64 exec, 1
  buffer_atomic_add v152, v1, s[24:27], s4 offen sc1
  s_mov_b64 exec, -1
prep_sga:
  s_branch prep_done
prep_done:
  s_load_dwordx2 s[16:17], s[0:1], 56
  v_and_b32 v2, 63, v0
  v_lshlrev_b32 v3, 2, v2
  v_lshlrev_b32 v2, 4, v2
  s_lshl_b32 s10, s21, 2
  s_add_u32 s12, s10, s23
  s_add_u32 s10, s10, s20
  s_and_b32 s4, s20, 1
  s_lshl_b32 s4, s4, 1
  s_add_u32 s12, s12, s4
  s_xor_b32 s13, s12, 2
  s_lshl_b32 s14, s22, 1
  s_lshr_b32 s4, s20, 1
  s_add_u32 s14, s14, s4
  s_xor_b32 s15, s14, 1
  s_mul_i32 s49, s12, 28
  s_lshl_b32 s4, s14, 1
  s_add_u32 s49, s49, s4
  s_lshl_b32 s49, s49, 10
  s_mul_i32 s11, s23, 7
  s_add_u32 s11, s11, s22
  s_lshl_b32 s11, s11, 2
  s_add_u32 s11, s11, s20
  s_mul_i32 s42, s20, 3072
  s_mul_i32 s43, s57, 86016
  s_add_u32 s43, s43, s42
  s_add_u32 s43, s43, 8388608
  s_mov_b32 s56, 0
  s_mov_b32 s59, 39845888
  s_mov_b32 s58, 20971520
  s_mov_b32 s60, 25165824
  s_mov_b32 s61, 27262976
  s_mov_b32 s28, 0
  s_mov_b32 s29, -1
  s_waitcnt lgkmcnt(0)
  s_cmp_eq_u32 s20, 0
  s_cbranch_scc0 w0d
  s_lshl_b32 s4, s21, 8
  s_lshl_b32 s5, s57, 8
  s_add_u32 s5, s5, 4096
  v_mov_b32 v12, s4
  v_mov_b32 v13, s5
  v_cndmask_b32 v12, v12, v13, s[28:29]
  v_cndmask_b32 v13, 16, 3, s[28:29]
  s_mov_b32 s4, 39886848
  s_mov_b32 s5, 0x8000
w0:
  buffer_load_dword v4, v12, s[24:27], s4 offen sc1
  s_sub_u32 s5, s5, 1
  s_cbranch_scc1 w0d
  s_waitcnt vmcnt(0)
  v_cmp_lt_u32 vcc, v4, v13
  s_cbranch_vccnz w0
w0d:
  s_barrier
  s_add_u32 m0, s42, 0
  s_add_u32 s45, s43, 0
  buffer_load_dwordx4 v2, s[24:27], s45 offen offset:0 sc1 lds
  buffer_load_dwordx4 v2, s[24:27], s45 offen offset:1024 sc1 lds
  buffer_load_dwordx4 v2, s[24:27], s45 offen offset:2048 sc1 lds
  s_add_u32 m0, s42, 12288
  s_add_u32 s45, s43, 12288
  buffer_load_dwordx4 v2, s[24:27], s45 offen offset:0 sc1 lds
  buffer_load_dwordx4 v2, s[24:27], s45 offen offset:1024 sc1 lds
  buffer_load_dwordx4 v2, s[24:27], s45 offen offset:2048 sc1 lds
  s_add_u32 m0, s42, 24576
  s_add_u32 s45, s43, 24576
  buffer_load_dwordx4 v2, s[24:27], s45 offen offset:0 sc1 lds
  buffer_load_dwordx4 v2, s[24:27], s45 offen offset:1024 sc1 lds
  buffer_load_dwordx4 v2, s[24:27], s45 offen offset:2048 sc1 lds
  s_add_u32 m0, s42, 36864
  s_add_u32 s45, s43, 36864
  buffer_load_dwordx4 v2, s[24:27], s45 offen offset:0 sc1 lds
  buffer_load_dwordx4 v2, s[24:27], s45 offen offset:1024 sc1 lds
  buffer_load_dwordx4 v2, s[24:27], s45 offen offset:2048 sc1 lds
  s_add_u32 m0, s42, 49152
  s_add_u32 s45, s43, 49152
  buffer_load_dwordx4 v2, s[24:27], s45 offen offset:0 sc1 lds
  buffer_load_dwordx4 v2, s[24:27], s45 offen offset:1024 sc1 lds
  buffer_load_dwordx4 v2, s[24:27], s45 offen offset:2048 sc1 lds
  s_add_u32 m0, s42, 61440
  s_add_u32 s45, s43, 61440
  buffer_load_dwordx4 v2, s[24:27], s45 offen offset:0 sc1 lds
  buffer_load_dwordx4 v2, s[24:27], s45 offen offset:1024 sc1 lds
  buffer_load_dwordx4 v2, s[24:27], s45 offen offset:2048 sc1 lds
  s_add_u32 m0, s42, 73728
  s_add_u32 s45, s43, 73728
  buffer_load_dwordx4 v2, s[24:27], s45 offen offset:0 sc1 lds
  buffer_load_dwordx4 v2, s[24:27], s45 offen offset:1024 sc1 lds
  buffer_load_dwordx4 v2, s[24:27], s45 offen offset:2048 sc1 lds
  buffer_load_dwordx4 v[248:251], v2, s[24:27], s49 offen sc1
  buffer_load_dwordx4 v[252:255], v2, s[24:27], s49 offen offset:1024 sc1
  s_xor_b32 s4, s20, 1
  s_mul_i32 s4, s4, 12288
  s_add_u32 s4, s4, 98304
  v_add_u32 v6, s4, v2
  s_xor_b32 s4, s20, 2
  s_mul_i32 s4, s4, 12288
  s_add_u32 s4, s4, 102400
  v_add_u32 v7, s4, v2
  s_xor_b32 s4, s20, 3
  s_mul_i32 s4, s4, 12288
  s_add_u32 s4, s4, 106496
  v_add_u32 v8, s4, v2
  s_mul_i32 s4, s20, 12288
  s_add_u32 s4, s4, 98304
  v_add_u32 v5, s4, v2
layer:
  s_mul_i32 s41, s10, 28672
  s_mul_i32 s4, s56, 4194304
  s_add_u32 s41, s41, s4
  s_lshl_b32 s44, s10, 12
  s_mul_i32 s4, s56, 524288
  s_add_u32 s44, s44, s4
  s_add_u32 s44, s44, 34603008
  s_add_u32 s46, s41, 0
  buffer_load_dwordx4 v[64:67], v2, s[24:27], s46 offen offset:0 sc1
  buffer_load_dwordx4 v[68:71], v2, s[24:27], s46 offen offset:1024 sc1
  buffer_load_dwordx4 v[72:75], v2, s[24:27], s46 offen offset:2048 sc1
  buffer_load_dwordx4 v[76:79], v2, s[24:27], s46 offen offset:3072 sc1
  s_add_u32 s46, s41, 4096
  buffer_load_dwordx4 v[80:83], v2, s[24:27], s46 offen offset:0 sc1
  buffer_load_dwordx4 v[84:87], v2, s[24:27], s46 offen offset:1024 sc1
  buffer_load_dwordx4 v[88:91], v2, s[24:27], s46 offen offset:2048 sc1
  buffer_load_dwordx4 v[92:95], v2, s[24:27], s46 offen offset:3072 sc1
  s_lshl_b32 s4, s20, 7
  s_add_u32 s4, s4, 94208
  v_and_b32 v12, 31, v0
  v_lshl_add_u32 v14, v12, 2, s4
  v_bfe_u32 v13, v0, 5, 1
  v_lshl_add_u32 v15, v13, 4, s4
  v_add_u32 v4, 0xc000, v2
  s_waitcnt vmcnt(8)
  s_barrier
  ds_read_b128 v[16:19], v2 offset:0
  ds_read_b128 v[20:23], v2 offset:1024
  ds_read_b128 v[24:27], v2 offset:2048
  ds_read_b128 v[28:31], v2 offset:3072
  ds_read_b128 v[32:35], v2 offset:4096
  ds_read_b128 v[36:39], v2 offset:5120
  s_waitcnt vmcnt(7)
  s_waitcnt lgkmcnt(3)
  v_mfma_f32_32x32x16_bf16 v[176:191], v[16:19], v[64:67], 0
  s_add_u32 s46, s41, 8192
  buffer_load_dwordx4 v[96:99], v2, s[24:27], s46 offen offset:0 sc1
  v_mfma_f32_32x32x16_bf16 v[192:207], v[20:23], v[64:67], 0
  v_mfma_f32_32x32x16_bf16 v[208:223], v[64:67], v[24:27], 0
  ds_read_b128 v[16:19], v2 offset:6144
  ds_read_b128 v[20:23], v2 offset:7168
  ds_read_b128 v[24:27], v2 offset:8192
  s_waitcnt vmcnt(7)
  s_waitcnt lgkmcnt(3)
  v_mfma_f32_32x32x16_bf16 v[176:191], v[28:31], v[68:71], v[176:191]
  buffer_load_dwordx4 v[100:103], v2, s[24:27], s46 offen offset:1024 sc1
  v_mfma_f32_32x32x16_bf16 v[192:207], v[32:35], v[68:71], v[192:207]
  v_mfma_f32_32x32x16_bf16 v[208:223], v[68:71], v[36:39], v[208:223]
  ds_read_b128 v[28:31], v2 offset:9216
  ds_read_b128 v[32:35], v2 offset:10240
  ds_read_b128 v[36:39], v2 offset:11264
  s_waitcnt vmcnt(7)
  s_waitcnt lgkmcnt(3)
  v_mfma_f32_32x32x16_bf16 v[176:191], v[16:19], v[72:75], v[176:191]
  buffer_load_dwordx4 v[104:107], v2, s[24:27], s46 offen offset:2048 sc1
  v_mfma_f32_32x32x16_bf16 v[192:207], v[20:23], v[72:75], v[192:207]
  v_mfma_f32_32x32x16_bf16 v[208:223], v[72:75], v[24:27], v[208:223]
  ds_read_b128 v[16:19], v2 offset:12288
  ds_read_b128 v[20:23], v2 offset:13312
  ds_read_b128 v[24:27], v2 offset:14336
  s_waitcnt vmcnt(7)
  s_waitcnt lgkmcnt(3)
  v_mfma_f32_32x32x16_bf16 v[176:191], v[28:31], v[76:79], v[176:191]
  buffer_load_dwordx4 v[108:111], v2, s[24:27], s46 offen offset:3072 sc1
  v_mfma_f32_32x32x16_bf16 v[192:207], v[32:35], v[76:79], v[192:207]
  v_mfma_f32_32x32x16_bf16 v[208:223], v[76:79], v[36:39], v[208:223]
  ds_read_b128 v[28:31], v2 offset:15360
  ds_read_b128 v[32:35], v2 offset:16384
  ds_read_b128 v[36:39], v2 offset:17408
  s_waitcnt vmcnt(7)
  s_waitcnt lgkmcnt(3)
  v_mfma_f32_32x32x16_bf16 v[176:191], v[16:19], v[80:83], v[176:191]
  s_add_u32 s46, s41, 12288
  buffer_load_dwordx4 v[112:115], v2, s[24:27], s46 offen offset:0 sc1
  v_mfma_f32_32x32x16_bf16 v[192:207], v[20:23], v[80:83], v[192:207]
  buffer_load_dword v40, v3, s[24:27], s44 offen offset:0 sc1
  v_mfma_f32_32x32x16_bf16 v[208:223], v[80:83], v[24:27], v[208:223]
  ds_read_b128 v[16:19], v2 offset:18432
  ds_read_b128 v[20:23], v2 offset:19456
  ds_read_b128 v[24:27], v2 offset:20480
  s_waitcnt vmcnt(8)
  s_waitcnt lgkmcnt(3)
  v_mfma_f32_32x32x16_bf16 v[176:191], v[28:31], v[84:87], v[176:191]
  buffer_load_dwordx4 v[116:119], v2, s[24:27], s46 offen offset:1024 sc1
  v_mfma_f32_32x32x16_bf16 v[192:207], v[32:35], v[84:87], v[192:207]
  buffer_load_dword v41, v3, s[24:27], s44 offen offset:256 sc1
  v_mfma_f32_32x32x16_bf16 v[208:223], v[84:87], v[36:39], v[208:223]
  ds_read_b128 v[28:31], v2 offset:21504
  ds_read_b128 v[32:35], v2 offset:22528
  ds_read_b128 v[36:39], v2 offset:23552
  s_waitcnt vmcnt(9)
  s_waitcnt lgkmcnt(3)
  v_mfma_f32_32x32x16_bf16 v[176:191], v[16:19], v[88:91], v[176:191]
  buffer_load_dwordx4 v[120:123], v2, s[24:27], s46 offen offset:2048 sc1
  v_mfma_f32_32x32x16_bf16 v[192:207], v[20:23], v[88:91], v[192:207]
  buffer_load_dword v42, v3, s[24:27], s44 offen offset:512 sc1
  v_mfma_f32_32x32x16_bf16 v[208:223], v[88:91], v[24:27], v[208:223]
  ds_read_b128 v[16:19], v2 offset:24576
  ds_read_b128 v[20:23], v2 offset:25600
  ds_read_b128 v[24:27], v2 offset:26624
  s_waitcnt vmcnt(10)
  s_waitcnt lgkmcnt(3)
  v_mfma_f32_32x32x16_bf16 v[176:191], v[28:31], v[92:95], v[176:191]
  buffer_load_dwordx4 v[124:127], v2, s[24:27], s46 offen offset:3072 sc1
  v_mfma_f32_32x32x16_bf16 v[192:207], v[32:35], v[92:95], v[192:207]
  buffer_load_dword v43, v3, s[24:27], s44 offen offset:768 sc1
  v_mfma_f32_32x32x16_bf16 v[208:223], v[92:95], v[36:39], v[208:223]
  ds_read_b128 v[28:31], v2 offset:27648
  ds_read_b128 v[32:35], v2 offset:28672
  ds_read_b128 v[36:39], v2 offset:29696
  s_waitcnt vmcnt(11)
  s_waitcnt lgkmcnt(3)
  v_mfma_f32_32x32x16_bf16 v[176:191], v[16:19], v[96:99], v[176:191]
  s_add_u32 s46, s41, 16384
  buffer_load_dwordx4 v[128:131], v2, s[24:27], s46 offen offset:0 sc1
  v_mfma_f32_32x32x16_bf16 v[192:207], v[20:23], v[96:99], v[192:207]
  buffer_load_dword v44, v3, s[24:27], s44 offen offset:1024 sc1
  v_mfma_f32_32x32x16_bf16 v[208:223], v[96:99], v[24:27], v[208:223]
  ds_read_b128 v[16:19], v2 offset:30720
  ds_read_b128 v[20:23], v2 offset:31744
  ds_read_b128 v[24:27], v2 offset:32768
  s_waitcnt vmcnt(12)
  s_waitcnt lgkmcnt(3)
  v_mfma_f32_32x32x16_bf16 v[176:191], v[28:31], v[100:103], v[176:191]
  buffer_load_dwordx4 v[132:135], v2, s[24:27], s46 offen offset:1024 sc1
  v_mfma_f32_32x32x16_bf16 v[192:207], v[32:35], v[100:103], v[192:207]
  buffer_load_dword v45, v3, s[24:27], s44 offen offset:1280 sc1
  v_mfma_f32_32x32x16_bf16 v[208:223], v[100:103], v[36:39], v[208:223]
  ds_read_b128 v[28:31], v2 offset:33792
  ds_read_b128 v[32:35], v2 offset:34816
  ds_read_b128 v[36:39], v2 offset:35840
  s_waitcnt vmcnt(13)
  s_waitcnt lgkmcnt(3)
  v_mfma_f32_32x32x16_bf16 v[176:191], v[16:19], v[104:107], v[176:191]
  buffer_load_dwordx4 v[136:139], v2, s[24:27], s46 offen offset:2048 sc1
  v_mfma_f32_32x32x16_bf16 v[192:207], v[20:23], v[104:107], v[192:207]
  buffer_load_dword v46, v3, s[24:27], s44 offen offset:1536 sc1
  v_mfma_f32_32x32x16_bf16 v[208:223], v[104:107], v[24:27], v[208:223]
  ds_read_b128 v[16:19], v2 offset:36864
  ds_read_b128 v[20:23], v2 offset:37888
  ds_read_b128 v[24:27], v2 offset:38912
  s_waitcnt vmcnt(14)
  s_waitcnt lgkmcnt(3)
  v_mfma_f32_32x32x16_bf16 v[176:191], v[28:31], v[108:111], v[176:191]
  buffer_load_dwordx4 v[140:143], v2, s[24:27], s46 offen offset:3072 sc1
  v_mfma_f32_32x32x16_bf16 v[192:207], v[32:35], v[108:111], v[192:207]
  buffer_load_dword v47, v3, s[24:27], s44 offen offset:1792 sc1
  v_mfma_f32_32x32x16_bf16 v[208:223], v[108:111], v[36:39], v[208:223]
  ds_read_b128 v[28:31], v2 offset:39936
  ds_read_b128 v[32:35], v2 offset:40960
  ds_read_b128 v[36:39], v2 offset:41984
  s_waitcnt vmcnt(15)
  s_waitcnt lgkmcnt(3)
  v_mfma_f32_32x32x16_bf16 v[176:191], v[16:19], v[112:115], v[176:191]
  s_add_u32 s46, s41, 20480
  buffer_load_dwordx4 v[144:147], v2, s[24:27], s46 offen offset:0 sc1
  v_mfma_f32_32x32x16_bf16 v[192:207], v[20:23], v[112:115], v[192:207]
  buffer_load_dword v48, v3, s[24:27], s44 offen offset:2048 sc1
  v_mfma_f32_32x32x16_bf16 v[208:223], v[112:115], v[24:27], v[208:223]
  ds_read_b128 v[16:19], v2 offset:43008
  ds_read_b128 v[20:23], v2 offset:44032
  ds_read_b128 v[24:27], v2 offset:45056
  s_waitcnt vmcnt(15)
  s_waitcnt lgkmcnt(3)
  v_mfma_f32_32x32x16_bf16 v[176:191], v[28:31], v[116:119], v[176:191]
  buffer_load_dwordx4 v[148:151], v2, s[24:27], s46 offen offset:1024 sc1
  v_mfma_f32_32x32x16_bf16 v[192:207], v[32:35], v[116:119], v[192:207]
  buffer_load_dword v49, v3, s[24:27], s44 offen offset:2304 sc1
  v_mfma_f32_32x32x16_bf16 v[208:223], v[116:119], v[36:39], v[208:223]
  ds_read_b128 v[28:31], v2 offset:46080
  ds_read_b128 v[32:35], v2 offset:47104
  ds_read_b128 v[36:39], v2 offset:48128
  s_waitcnt vmcnt(15)
  s_waitcnt lgkmcnt(3)
  v_mfma_f32_32x32x16_bf16 v[176:191], v[16:19], v[120:123], v[176:191]
  buffer_load_dwordx4 v[152:155], v2, s[24:27], s46 offen offset:2048 sc1
  v_mfma_f32_32x32x16_bf16 v[192:207], v[20:23], v[120:123], v[192:207]
  buffer_load_dword v50, v3, s[24:27], s44 offen offset:2560 sc1
  v_mfma_f32_32x32x16_bf16 v[208:223], v[120:123], v[24:27], v[208:223]
  ds_read_b128 v[16:19], v4 offset:0
  ds_read_b128 v[20:23], v4 offset:1024
  ds_read_b128 v[24:27], v4 offset:2048
  s_waitcnt vmcnt(15)
  s_waitcnt lgkmcnt(3)
  v_mfma_f32_32x32x16_bf16 v[176:191], v[28:31], v[124:127], v[176:191]
  buffer_load_dwordx4 v[156:159], v2, s[24:27], s46 offen offset:3072 sc1
  v_mfma_f32_32x32x16_bf16 v[192:207], v[32:35], v[124:127], v[192:207]
  buffer_load_dword v51, v3, s[24:27], s44 offen offset:2816 sc1
  v_mfma_f32_32x32x16_bf16 v[208:223], v[124:127], v[36:39], v[208:223]
  ds_read_b128 v[28:31], v4 offset:3072
  ds_read_b128 v[32:35], v4 offset:4096
  ds_read_b128 v[36:39], v4 offset:5120
  s_waitcnt vmcnt(15)
  s_waitcnt lgkmcnt(3)
  v_mfma_f32_32x32x16_bf16 v[176:191], v[16:19], v[128:131], v[176:191]
  s_add_u32 s46, s41, 24576
  buffer_load_dwordx4 v[160:163], v2, s[24:27], s46 offen offset:0 sc1
  v_mfma_f32_32x32x16_bf16 v[192:207], v[20:23], v[128:131], v[192:207]
  buffer_load_dword v52, v3, s[24:27], s44 offen offset:3072 sc1
  v_mfma_f32_32x32x16_bf16 v[208:223], v[128:131], v[24:27], v[208:223]
  ds_read_b128 v[16:19], v4 offset:6144
  ds_read_b128 v[20:23], v4 offset:7168
  ds_read_b128 v[24:27], v4 offset:8192
  s_waitcnt vmcnt(15)
  s_waitcnt lgkmcnt(3)
  v_mfma_f32_32x32x16_bf16 v[176:191], v[28:31], v[132:135], v[176:191]
  buffer_load_dwordx4 v[164:167], v2, s[24:27], s46 offen offset:1024 sc1
  v_mfma_f32_32x32x16_bf16 v[192:207], v[32:35], v[132:135], v[192:207]
  buffer_load_dword v53, v3, s[24:27], s44 offen offset:3328 sc1
  v_mfma_f32_32x32x16_bf16 v[208:223], v[132:135], v[36:39], v[208:223]
  ds_read_b128 v[28:31], v4 offset:9216
  ds_read_b128 v[32:35], v4 offset:10240
  ds_read_b128 v[36:39], v4 offset:11264
  s_waitcnt vmcnt(15)
  s_waitcnt lgkmcnt(3)
  v_mfma_f32_32x32x16_bf16 v[176:191], v[16:19], v[136:139], v[176:191]
  buffer_load_dwordx4 v[168:171], v2, s[24:27], s46 offen offset:2048 sc1
  v_mfma_f32_32x32x16_bf16 v[192:207], v[20:23], v[136:139], v[192:207]
  v_mfma_f32_32x32x16_bf16 v[208:223], v[136:139], v[24:27], v[208:223]
  ds_read_b128 v[16:19], v4 offset:12288
  ds_read_b128 v[20:23], v4 offset:13312
  ds_read_b128 v[24:27], v4 offset:14336
  s_waitcnt vmcnt(14)
  s_waitcnt lgkmcnt(3)
  v_mfma_f32_32x32x16_bf16 v[176:191], v[28:31], v[140:143], v[176:191]
  buffer_load_dwordx4 v[172:175], v2, s[24:27], s46 offen offset:3072 sc1
  v_mfma_f32_32x32x16_bf16 v[192:207], v[32:35], v[140:143], v[192:207]
  v_mfma_f32_32x32x16_bf16 v[208:223], v[140:143], v[36:39], v[208:223]
  ds_read_b128 v[28:31], v4 offset:15360
  ds_read_b128 v[32:35], v4 offset:16384
  ds_read_b128 v[36:39], v4 offset:17408
  s_waitcnt vmcnt(13)
  s_waitcnt lgkmcnt(3)
  v_mfma_f32_32x32x16_bf16 v[176:191], v[16:19], v[144:147], v[176:191]
  v_mfma_f32_32x32x16_bf16 v[192:207], v[20:23], v[144:147], v[192:207]
  v_mfma_f32_32x32x16_bf16 v[208:223], v[144:147], v[24:27], v[208:223]
  ds_read_b128 v[16:19], v4 offset:18432
  ds_read_b128 v[20:23], v4 offset:19456
  ds_read_b128 v[24:27], v4 offset:20480
  s_waitcnt vmcnt(11)
  s_waitcnt lgkmcnt(3)
  v_mfma_f32_32x32x16_bf16 v[176:191], v[28:31], v[148:151], v[176:191]
  v_mfma_f32_32x32x16_bf16 v[192:207], v[32:35], v[148:151], v[192:207]
  v_mfma_f32_32x32x16_bf16 v[208:223], v[148:151], v[36:39], v[208:223]
  s_waitcnt vmcnt(2)
  v_add_f32 v40, v40, v47
  v_add_f32 v41, v41, v48
  v_add_f32 v42, v42, v49
  v_add_f32 v43, v43, v50
  v_add_f32 v44, v44, v51
  v_add_f32 v45, v45, v52
  v_add_f32 v46, v46, v53
  v_add_f32 v40, v40, v41
  v_add_f32 v42, v42, v43
  v_add_f32 v44, v44, v45
  v_add_f32 v40, v40, v46
  v_add_f32 v42, v42, v44
  v_add_f32 v40, v40, v42
  v_mul_f32 v40, 0x3b124925, v40
  v_mov_b32 v41, v40
  s_nop 1
  v_permlane32_swap_b32 v40, v41
  s_nop 1
  v_fma_f32 v40, -v40, v40, v41
  v_max_f32 v40, 0, v40
  v_add_f32 v40, 0x3727c5ac, v40
  v_rsq_f32 v40, v40
  s_nop 0
  ds_write_b32 v14, v40
  ds_read_b128 v[224:227], v15 offset:0
  ds_read_b128 v[228:231], v15 offset:32
  ds_read_b128 v[232:235], v15 offset:64
  ds_read_b128 v[236:239], v15 offset:96
  ds_read_b128 v[28:31], v4 offset:21504
  ds_read_b128 v[32:35], v4 offset:22528
  ds_read_b128 v[36:39], v4 offset:23552
  s_waitcnt lgkmcnt(3)
  v_mfma_f32_32x32x16_bf16 v[176:191], v[16:19], v[152:155], v[176:191]
  v_mfma_f32_32x32x16_bf16 v[192:207], v[20:23], v[152:155], v[192:207]
  v_mfma_f32_32x32x16_bf16 v[208:223], v[152:155], v[24:27], v[208:223]
  ds_read_b128 v[16:19], v4 offset:24576
  ds_read_b128 v[20:23], v4 offset:25600
  ds_read_b128 v[24:27], v4 offset:26624
  s_waitcnt lgkmcnt(3)
  v_mfma_f32_32x32x16_bf16 v[176:191], v[28:31], v[156:159], v[176:191]
  v_mfma_f32_32x32x16_bf16 v[192:207], v[32:35], v[156:159], v[192:207]
  v_mfma_f32_32x32x16_bf16 v[208:223], v[156:159], v[36:39], v[208:223]
  ds_read_b128 v[28:31], v4 offset:27648
  ds_read_b128 v[32:35], v4 offset:28672
  ds_read_b128 v[36:39], v4 offset:29696
  s_waitcnt lgkmcnt(3)
  v_mfma_f32_32x32x16_bf16 v[176:191], v[16:19], v[160:163], v[176:191]
  v_mfma_f32_32x32x16_bf16 v[192:207], v[20:23], v[160:163], v[192:207]
  v_mfma_f32_32x32x16_bf16 v[208:223], v[160:163], v[24:27], v[208:223]
  ds_read_b128 v[16:19], v4 offset:30720
  ds_read_b128 v[20:23], v4 offset:31744
  ds_read_b128 v[24:27], v4 offset:32768
  s_waitcnt lgkmcnt(3)
  v_mfma_f32_32x32x16_bf16 v[176:191], v[28:31], v[164:167], v[176:191]
  v_mfma_f32_32x32x16_bf16 v[192:207], v[32:35], v[164:167], v[192:207]
  v_mfma_f32_32x32x16_bf16 v[208:223], v[164:167], v[36:39], v[208:223]
  ds_read_b128 v[28:31], v4 offset:33792
  ds_read_b128 v[32:35], v4 offset:34816
  ds_read_b128 v[36:39], v4 offset:35840
  s_waitcnt vmcnt(1)
  s_waitcnt lgkmcnt(3)
  v_mfma_f32_32x32x16_bf16 v[176:191], v[16:19], v[168:171], v[176:191]
  v_mfma_f32_32x32x16_bf16 v[192:207], v[20:23], v[168:171], v[192:207]
  v_mfma_f32_32x32x16_bf16 v[208:223], v[168:171], v[24:27], v[208:223]
  s_waitcnt vmcnt(0)
  s_waitcnt lgkmcnt(0)
  v_mfma_f32_32x32x16_bf16 v[176:191], v[28:31], v[172:175], v[176:191]
  v_mfma_f32_32x32x16_bf16 v[192:207], v[32:35], v[172:175], v[192:207]
  v_mfma_f32_32x32x16_bf16 v[208:223], v[172:175], v[36:39], v[208:223]
  s_lshl_b32 s47, s57, 6
  s_add_u32 s47, s47, s10
  s_lshl_b32 s47, s47, 12
  s_add_u32 s47, s47, s58
  v_cmp_eq_u32 s[30:31], 28, v12
  v_mul_f32 v41, 0x3e8b97f6, v40
  v_mov_b32 v9, 0x3f803f80
  v_mov_b32 v10, 0x3f80
  v_mov_b32 v11, 95232
  s_lshl_b32 s4, s20, 11
  s_add_u32 s4, s4, 86016
  v_add_u32 v13, s4, v2
  ds_write_b32 v11, v1
  s_nop 2
  v_mul_f32 v192, v40, v192
  v_mul_f32 v193, v40, v193
  v_mul_f32 v194, v40, v194
  v_mul_f32 v195, v40, v195
  v_mul_f32 v196, v40, v196
  v_mul_f32 v197, v40, v197
  v_mul_f32 v198, v40, v198
  v_mul_f32 v199, v40, v199
  v_mul_f32 v200, v40, v200
  v_mul_f32 v201, v40, v201
  v_mul_f32 v202, v40, v202
  v_mul_f32 v203, v40, v203
  v_mul_f32 v204, v40, v204
  v_mul_f32 v205, v40, v205
  v_mul_f32 v206, v40, v206
  v_mul_f32 v207, v40, v207
  v_cvt_pk_bf16_f32 v72, v192, v193
  v_cvt_pk_bf16_f32 v73, v194, v195
  v_cvt_pk_bf16_f32 v74, v196, v197
  v_cvt_pk_bf16_f32 v75, v198, v199
  v_cvt_pk_bf16_f32 v76, v200, v201
  v_cvt_pk_bf16_f32 v77, v202, v203
  v_cvt_pk_bf16_f32 v78, v204, v205
  v_cvt_pk_bf16_f32 v79, v206, v207
  v_cndmask_b32 v78, v78, v9, s[28:29]
  v_cndmask_b32 v79, v79, v10, s[28:29]
  buffer_store_dwordx4 v[72:75], v2, s[24:27], s47 offen offset:0 sc1
  buffer_store_dwordx4 v[76:79], v2, s[24:27], s47 offen offset:1024 sc1
  v_mul_f32 v208, v224, v208
  v_mul_f32 v209, v225, v209
  v_mul_f32 v210, v226, v210
  v_mul_f32 v211, v227, v211
  v_mul_f32 v212, v228, v212
  v_mul_f32 v213, v229, v213
  v_mul_f32 v214, v230, v214
  v_mul_f32 v215, v231, v215
  v_mul_f32 v216, v232, v216
  v_mul_f32 v217, v233, v217
  v_mul_f32 v218, v234, v218
  v_mul_f32 v219, v235, v219
  v_mul_f32 v220, v236, v220
  v_mul_f32 v221, v237, v221
  v_mul_f32 v222, v238, v222
  v_mul_f32 v223, v239, v223
  v_cvt_pk_bf16_f32 v80, v208, v209
  v_cvt_pk_bf16_f32 v81, v210, v211
  v_cvt_pk_bf16_f32 v82, v212, v213
  v_cvt_pk_bf16_f32 v83, v214, v215
  v_cvt_pk_bf16_f32 v84, v216, v217
  v_cvt_pk_bf16_f32 v85, v218, v219
  v_cvt_pk_bf16_f32 v86, v220, v221
  v_cvt_pk_bf16_f32 v87, v222, v223
  v_cndmask_b32 v80, v80, v9, s[30:31]
  v_cndmask_b32 v81, v81, v9, s[30:31]
  v_cndmask_b32 v82, v82, v9, s[30:31]
  v_cndmask_b32 v83, v83, v9, s[30:31]
  v_cndmask_b32 v84, v84, v9, s[30:31]
  v_cndmask_b32 v85, v85, v9, s[30:31]
  v_cndmask_b32 v86, v86, v9, s[30:31]
  v_cndmask_b32 v87, v87, v9, s[30:31]
  buffer_store_dwordx4 v[80:83], v2, s[24:27], s47 offen offset:2048 sc1
  buffer_store_dwordx4 v[84:87], v2, s[24:27], s47 offen offset:3072 sc1
  s_waitcnt vmcnt(0) lgkmcnt(0)
  s_barrier
  s_cmp_eq_u32 s20, 0
  s_cbranch_scc0 sig1
  s_lshl_b32 s4, s57, 8
  s_add_u32 s4, s4, s59
  s_add_u32 s4, s4, 0
  s_mov_b64 exec, 1
  v_mov_b32 v4, 1
  buffer_atomic_add v4, v1, s[24:27], s4 offen sc1
  s_cmp_eq_u32 s56, 0
  s_cbranch_scc0 wdn0
  s_lshl_b32 s4, s21, 8
  s_add_u32 s4, s4, 39886976
  buffer_atomic_add v4, v1, s[24:27], s4 offen sc1
wdn0:
  s_mov_b64 exec, -1
sig1:
  v_mul_f32 v176, v41, v176
  v_mul_f32 v177, v41, v177
  v_mul_f32 v178, v41, v178
  v_mul_f32 v179, v41, v179
  v_mul_f32 v180, v41, v180
  v_mul_f32 v181, v41, v181
  v_mul_f32 v182, v41, v182
  v_mul_f32 v183, v41, v183
  v_mul_f32 v184, v41, v184
  v_mul_f32 v185, v41, v185
  v_mul_f32 v186, v41, v186
  v_mul_f32 v187, v41, v187
  v_mul_f32 v188, v41, v188
  v_mul_f32 v189, v41, v189
  v_mul_f32 v190, v41, v190
  v_mul_f32 v191, v41, v191
  v_cvt_pk_bf16_f32 v64, v176, v177
  v_cvt_pk_bf16_f32 v65, v178, v179
  v_cvt_pk_bf16_f32 v66, v180, v181
  v_cvt_pk_bf16_f32 v67, v182, v183
  v_cvt_pk_bf16_f32 v68, v184, v185
  v_cvt_pk_bf16_f32 v69, v186, v187
  v_cvt_pk_bf16_f32 v70, v188, v189
  v_cvt_pk_bf16_f32 v71, v190, v191
  v_cndmask_b32 v70, v70, v1, s[28:29]
  v_cndmask_b32 v71, v71, v1, s[28:29]
  s_nop 1
  v_mfma_f32_32x32x16_bf16 v[96:111], v[72:75], v[64:67], 0
  v_mfma_f32_32x32x16_bf16 v[96:111], v[76:79], v[68:71], v[96:111]
  s_nop 15
  v_max3_f32 v16, v96, v97, v98
  v_max3_f32 v16, v16, v99, v100
  v_max3_f32 v16, v16, v101, v102
  v_max3_f32 v16, v16, v103, v104
  v_max3_f32 v16, v16, v105, v106
  v_max3_f32 v16, v16, v107, v108
  v_max3_f32 v16, v16, v109, v110
  v_max_f32 v16, v16, v111
  v_mov_b32 v17, v16
  s_nop 1
  v_permlane32_swap_b32 v16, v17
  s_nop 1
  v_max_f32 v16, v16, v17
  v_cvt_pk_bf16_f32 v16, -v16, 0
  v_cndmask_b32 v70, v70, v16, s[28:29]
  ds_write_b128 v13, v[64:67]
  ds_write_b128 v13, v[68:71] offset:1024
  s_lshl_b32 s44, s57, 18
  s_add_u32 s44, s44, s58
  s_lshl_b32 s4, s20, 16
  s_add_u32 s44, s44, s4
  s_mov_b32 s52, 0
  s_lshl_b32 s50, s14, 15
  s_lshl_b32 s51, s15, 15
  s_lshl_b32 s4, s20, 13
  s_add_u32 s4, s4, 10485760
  s_add_u32 s50, s50, s4
  s_add_u32 s51, s51, s4
  s_mul_i32 s53, s11, 57344
  s_add_u32 s53, s53, 12582912
  v_and_b32 v220, 15, v0
  v_lshlrev_b32 v220, 8, v220
  s_mov_b32 s48, 39886976
  s_cmp_eq_u32 s20, 0
  s_cbranch_scc0 wt2d
  s_lshl_b32 s4, s57, 8
  s_add_u32 s4, s4, s59
  s_add_u32 s4, s4, 0
  s_mov_b32 s5, 0x8000
wt2:
  buffer_load_dword v4, v1, s[24:27], s4 offen sc1
  s_sub_u32 s5, s5, 1
  s_cbranch_scc1 wt2d
  s_waitcnt vmcnt(0)
  v_readfirstlane_b32 s6, v4
  s_cmp_lt_u32 s6, 16
  s_cbranch_scc1 wt2
wt2d:
  s_waitcnt lgkmcnt(0)
  s_barrier
  s_add_u32 s45, s44, 0
  buffer_load_dwordx4 v[156:159], v2, s[24:27], s45 offen offset:0 sc1
  buffer_load_dwordx4 v[160:163], v2, s[24:27], s45 offen offset:1024 sc1
  buffer_load_dwordx4 v[164:167], v2, s[24:27], s45 offen offset:2048 sc1
  buffer_load_dwordx4 v[168:171], v2, s[24:27], s45 offen offset:3072 sc1
  s_xor_b32 s4, s20, 0
  s_lshl_b32 s4, s4, 11
  s_add_u32 s4, s4, 86016
  v_add_u32 v4, s4, v2
  ds_read_b128 v[12:15], v4
  ds_read_b128 v[16:19], v4 offset:1024
  s_xor_b32 s4, s20, 1
  s_lshl_b32 s4, s4, 11
  s_add_u32 s4, s4, 86016
  v_add_u32 v4, s4, v2
  ds_read_b128 v[20:23], v4
  ds_read_b128 v[24:27], v4 offset:1024
  s_xor_b32 s4, s20, 2
  s_lshl_b32 s4, s4, 11
  s_add_u32 s4, s4, 86016
  v_add_u32 v4, s4, v2
  ds_read_b128 v[28:31], v4
  ds_read_b128 v[32:35], v4 offset:1024
  s_xor_b32 s4, s20, 3
  s_lshl_b32 s4, s4, 11
  s_add_u32 s4, s4, 86016
  v_add_u32 v4, s4, v2
  ds_read_b128 v[36:39], v4
  ds_read_b128 v[40:43], v4 offset:1024
attn_main:
  s_add_u32 s45, s44, 4096
  buffer_load_dwordx4 v[172:175], v2, s[24:27], s45 offen offset:0 sc1
  buffer_load_dwordx4 v[176:179], v2, s[24:27], s45 offen offset:1024 sc1
  buffer_load_dwordx4 v[180:183], v2, s[24:27], s45 offen offset:2048 sc1
  buffer_load_dwordx4 v[184:187], v2, s[24:27], s45 offen offset:3072 sc1
  s_add_u32 s45, s44, 8192
  buffer_load_dwordx4 v[188:191], v2, s[24:27], s45 offen offset:0 sc1
  buffer_load_dwordx4 v[192:195], v2, s[24:27], s45 offen offset:1024 sc1
  buffer_load_dwordx4 v[196:199], v2, s[24:27], s45 offen offset:2048 sc1
  buffer_load_dwordx4 v[200:203], v2, s[24:27], s45 offen offset:3072 sc1
  s_waitcnt lgkmcnt(0)
  s_waitcnt vmcnt(8)
  v_mfma_f32_32x32x16_bf16 v[108:123], v[156:159], v[12:15], 0
  v_mfma_f32_32x32x16_bf16 v[108:123], v[160:163], v[16:19], v[108:123]
  s_nop 10
  v_mfma_f32_32x32x16_bf16 v[124:139], v[156:159], v[20:23], 0
  v_exp_f32 v108, v108
  v_exp_f32 v109, v109
  v_exp_f32 v110, v110
  v_exp_f32 v111, v111
  v_mfma_f32_32x32x16_bf16 v[124:139], v[160:163], v[24:27], v[124:139]
  v_exp_f32 v112, v112
  v_exp_f32 v113, v113
  v_exp_f32 v114, v114
  v_exp_f32 v115, v115
  v_cvt_pk_bf16_f32 v140, v108, v109
  v_cvt_pk_bf16_f32 v141, v110, v111
  s_add_u32 s45, s44, 12288
  buffer_load_dwordx4 v[204:207], v2, s[24:27], s45 offen offset:0 sc1
  v_exp_f32 v116, v116
  v_exp_f32 v117, v117
  v_exp_f32 v118, v118
  v_exp_f32 v119, v119
  v_cvt_pk_bf16_f32 v142, v112, v113
  v_cvt_pk_bf16_f32 v143, v114, v115
  v_exp_f32 v120, v120
  v_exp_f32 v121, v121
  v_mfma_f32_32x32x16_bf16 v[44:59], v[164:167], v[140:143], 0
  v_exp_f32 v122, v122
  v_exp_f32 v123, v123
  v_cvt_pk_bf16_f32 v144, v116, v117
  v_cvt_pk_bf16_f32 v145, v118, v119
  v_cvt_pk_bf16_f32 v146, v120, v121
  v_cvt_pk_bf16_f32 v147, v122, v123
  v_mfma_f32_32x32x16_bf16 v[108:123], v[156:159], v[28:31], 0
  v_exp_f32 v124, v124
  v_exp_f32 v125, v125
  v_exp_f32 v126, v126
  v_exp_f32 v127, v127
  v_mfma_f32_32x32x16_bf16 v[108:123], v[160:163], v[32:35], v[108:123]
  v_exp_f32 v128, v128
  v_exp_f32 v129, v129
  v_exp_f32 v130, v130
  v_exp_f32 v131, v131
  v_cvt_pk_bf16_f32 v148, v124, v125
  v_cvt_pk_bf16_f32 v149, v126, v127
  v_mfma_f32_32x32x16_bf16 v[44:59], v[168:171], v[144:147], v[44:59]
  buffer_load_dwordx4 v[208:211], v2, s[24:27], s45 offen offset:1024 sc1
  v_exp_f32 v132, v132
  v_exp_f32 v133, v133
  v_exp_f32 v134, v134
  v_exp_f32 v135, v135
  v_cvt_pk_bf16_f32 v150, v128, v129
  v_cvt_pk_bf16_f32 v151, v130, v131
  v_exp_f32 v136, v136
  v_exp_f32 v137, v137
  v_mfma_f32_32x32x16_bf16 v[60:75], v[164:167], v[148:151], 0
  v_exp_f32 v138, v138
  v_exp_f32 v139, v139
  v_cvt_pk_bf16_f32 v152, v132, v133
  v_cvt_pk_bf16_f32 v153, v134, v135
  v_cvt_pk_bf16_f32 v154, v136, v137
  v_cvt_pk_bf16_f32 v155, v138, v139
  v_mfma_f32_32x32x16_bf16 v[124:139], v[156:159], v[36:39], 0
  v_exp_f32 v108, v108
  v_exp_f32 v109, v109
  v_exp_f32 v110, v110
  v_exp_f32 v111, v111
  v_mfma_f32_32x32x16_bf16 v[124:139], v[160:163], v[40:43], v[124:139]
  v_exp_f32 v112, v112
  v_exp_f32 v113, v113
  v_exp_f32 v114, v114
  v_exp_f32 v115, v115
  v_cvt_pk_bf16_f32 v140, v108, v109
  v_cvt_pk_bf16_f32 v141, v110, v111
  v_mfma_f32_32x32x16_bf16 v[60:75], v[168:171], v[152:155], v[60:75]
  buffer_load_dwordx4 v[212:215], v2, s[24:27], s45 offen offset:2048 sc1
  v_exp_f32 v116, v116
  v_exp_f32 v117, v117
  v_exp_f32 v118, v118
  v_exp_f32 v119, v119
  v_cvt_pk_bf16_f32 v142, v112, v113
  v_cvt_pk_bf16_f32 v143, v114, v115
  v_exp_f32 v120, v120
  v_exp_f32 v121, v121
  v_mfma_f32_32x32x16_bf16 v[76:91], v[164:167], v[140:143], 0
  v_exp_f32 v122, v122
  v_exp_f32 v123, v123
  v_cvt_pk_bf16_f32 v144, v116, v117
  v_cvt_pk_bf16_f32 v145, v118, v119
  v_cvt_pk_bf16_f32 v146, v120, v121
  v_cvt_pk_bf16_f32 v147, v122, v123
  s_waitcnt vmcnt(7)
  v_mfma_f32_32x32x16_bf16 v[108:123], v[172:175], v[12:15], 0
  v_exp_f32 v124, v124
  v_exp_f32 v125, v125
  v_exp_f32 v126, v126
  v_exp_f32 v127, v127
  v_mfma_f32_32x32x16_bf16 v[108:123], v[176:179], v[16:19], v[108:123]
  v_exp_f32 v128, v128
  v_exp_f32 v129, v129
  v_exp_f32 v130, v130
  v_exp_f32 v131, v131
  v_cvt_pk_bf16_f32 v148, v124, v125
  v_cvt_pk_bf16_f32 v149, v126, v127
  v_mfma_f32_32x32x16_bf16 v[76:91], v[168:171], v[144:147], v[76:91]
  buffer_load_dwordx4 v[216:219], v2, s[24:27], s45 offen offset:3072 sc1
  v_exp_f32 v132, v132
  v_exp_f32 v133, v133
  v_exp_f32 v134, v134
  v_exp_f32 v135, v135
  v_cvt_pk_bf16_f32 v150, v128, v129
  v_cvt_pk_bf16_f32 v151, v130, v131
  v_exp_f32 v136, v136
  v_exp_f32 v137, v137
  v_mfma_f32_32x32x16_bf16 v[92:107], v[164:167], v[148:151], 0
  v_exp_f32 v138, v138
  v_exp_f32 v139, v139
  v_cvt_pk_bf16_f32 v152, v132, v133
  v_cvt_pk_bf16_f32 v153, v134, v135
  v_cvt_pk_bf16_f32 v154, v136, v137
  v_cvt_pk_bf16_f32 v155, v138, v139
  v_mfma_f32_32x32x16_bf16 v[124:139], v[172:175], v[20:23], 0
  v_exp_f32 v108, v108
  v_exp_f32 v109, v109
  v_exp_f32 v110, v110
  v_exp_f32 v111, v111
  v_mfma_f32_32x32x16_bf16 v[124:139], v[176:179], v[24:27], v[124:139]
  v_exp_f32 v112, v112
  v_exp_f32 v113, v113
  v_exp_f32 v114, v114
  v_exp_f32 v115, v115
  v_cvt_pk_bf16_f32 v140, v108, v109
  v_cvt_pk_bf16_f32 v141, v110, v111
  v_mfma_f32_32x32x16_bf16 v[92:107], v[168:171], v[152:155], v[92:107]
  s_add_u32 s45, s44, 16384
  buffer_load_dwordx4 v[156:159], v2, s[24:27], s45 offen offset:0 sc1
  v_exp_f32 v116, v116
  v_exp_f32 v117, v117
  v_exp_f32 v118, v118
  v_exp_f32 v119, v119
  v_cvt_pk_bf16_f32 v142, v112, v113
  v_cvt_pk_bf16_f32 v143, v114, v115
  v_exp_f32 v120, v120
  v_exp_f32 v121, v121
  v_mfma_f32_32x32x16_bf16 v[44:59], v[180:183], v[140:143], v[44:59]
  v_exp_f32 v122, v122
  v_exp_f32 v123, v123
  v_cvt_pk_bf16_f32 v144, v116, v117
  v_cvt_pk_bf16_f32 v145, v118, v119
  v_cvt_pk_bf16_f32 v146, v120, v121
  v_cvt_pk_bf16_f32 v147, v122, v123
  v_mfma_f32_32x32x16_bf16 v[108:123], v[172:175], v[28:31], 0
  v_exp_f32 v124, v124
  v_exp_f32 v125, v125
  v_exp_f32 v126, v126
  v_exp_f32 v127, v127
  v_mfma_f32_32x32x16_bf16 v[108:123], v[176:179], v[32:35], v[108:123]
  v_exp_f32 v128, v128
  v_exp_f32 v129, v129
  v_exp_f32 v130, v130
  v_exp_f32 v131, v131
  v_cvt_pk_bf16_f32 v148, v124, v125
  v_cvt_pk_bf16_f32 v149, v126, v127
  v_mfma_f32_32x32x16_bf16 v[44:59], v[184:187], v[144:147], v[44:59]
  buffer_load_dwordx4 v[160:163], v2, s[24:27], s45 offen offset:1024 sc1
  v_exp_f32 v132, v132
  v_exp_f32 v133, v133
  v_exp_f32 v134, v134
  v_exp_f32 v135, v135
  v_cvt_pk_bf16_f32 v150, v128, v129
  v_cvt_pk_bf16_f32 v151, v130, v131
  v_exp_f32 v136, v136
  v_exp_f32 v137, v137
  v_mfma_f32_32x32x16_bf16 v[60:75], v[180:183], v[148:151], v[60:75]
  v_exp_f32 v138, v138
  v_exp_f32 v139, v139
  v_cvt_pk_bf16_f32 v152, v132, v133
  v_cvt_pk_bf16_f32 v153, v134, v135
  v_cvt_pk_bf16_f32 v154, v136, v137
  v_cvt_pk_bf16_f32 v155, v138, v139
  v_mfma_f32_32x32x16_bf16 v[124:139], v[172:175], v[36:39], 0
  v_exp_f32 v108, v108
  v_exp_f32 v109, v109
  v_exp_f32 v110, v110
  v_exp_f32 v111, v111
  v_mfma_f32_32x32x16_bf16 v[124:139], v[176:179], v[40:43], v[124:139]
  v_exp_f32 v112, v112
  v_exp_f32 v113, v113
  v_exp_f32 v114, v114
  v_exp_f32 v115, v115
  v_cvt_pk_bf16_f32 v140, v108, v109
  v_cvt_pk_bf16_f32 v141, v110, v111
  v_mfma_f32_32x32x16_bf16 v[60:75], v[184:187], v[152:155], v[60:75]
  buffer_load_dwordx4 v[164:167], v2, s[24:27], s45 offen offset:2048 sc1
  v_exp_f32 v116, v116
  v_exp_f32 v117, v117
  v_exp_f32 v118, v118
  v_exp_f32 v119, v119
  v_cvt_pk_bf16_f32 v142, v112, v113
  v_cvt_pk_bf16_f32 v143, v114, v115
  v_exp_f32 v120, v120
  v_exp_f32 v121, v121
  v_mfma_f32_32x32x16_bf16 v[76:91], v[180:183], v[140:143], v[76:91]
  v_exp_f32 v122, v122
  v_exp_f32 v123, v123
  v_cvt_pk_bf16_f32 v144, v116, v117
  v_cvt_pk_bf16_f32 v145, v118, v119
  v_cvt_pk_bf16_f32 v146, v120, v121
  v_cvt_pk_bf16_f32 v147, v122, v123
  s_waitcnt vmcnt(7)
  v_mfma_f32_32x32x16_bf16 v[108:123], v[188:191], v[12:15], 0
  v_exp_f32 v124, v124
  v_exp_f32 v125, v125
  v_exp_f32 v126, v126
  v_exp_f32 v127, v127
  v_mfma_f32_32x32x16_bf16 v[108:123], v[192:195], v[16:19], v[108:123]
  v_exp_f32 v128, v128
  v_exp_f32 v129, v129
  v_exp_f32 v130, v130
  v_exp_f32 v131, v131
  v_cvt_pk_bf16_f32 v148, v124, v125
  v_cvt_pk_bf16_f32 v149, v126, v127
  v_mfma_f32_32x32x16_bf16 v[76:91], v[184:187], v[144:147], v[76:91]
  buffer_load_dwordx4 v[168:171], v2, s[24:27], s45 offen offset:3072 sc1
  v_exp_f32 v132, v132
  v_exp_f32 v133, v133
  v_exp_f32 v134, v134
  v_exp_f32 v135, v135
  v_cvt_pk_bf16_f32 v150, v128, v129
  v_cvt_pk_bf16_f32 v151, v130, v131
  v_exp_f32 v136, v136
  v_exp_f32 v137, v137
  v_mfma_f32_32x32x16_bf16 v[92:107], v[180:183], v[148:151], v[92:107]
  v_exp_f32 v138, v138
  v_exp_f32 v139, v139
  v_cvt_pk_bf16_f32 v152, v132, v133
  v_cvt_pk_bf16_f32 v153, v134, v135
  v_cvt_pk_bf16_f32 v154, v136, v137
  v_cvt_pk_bf16_f32 v155, v138, v139
  v_mfma_f32_32x32x16_bf16 v[124:139], v[188:191], v[20:23], 0
  v_exp_f32 v108, v108
  v_exp_f32 v109, v109
  v_exp_f32 v110, v110
  v_exp_f32 v111, v111
  v_mfma_f32_32x32x16_bf16 v[124:139], v[192:195], v[24:27], v[124:139]
  v_exp_f32 v112, v112
  v_exp_f32 v113, v113
  v_exp_f32 v114, v114
  v_exp_f32 v115, v115
  v_cvt_pk_bf16_f32 v140, v108, v109
  v_cvt_pk_bf16_f32 v141, v110, v111
  v_mfma_f32_32x32x16_bf16 v[92:107], v[184:187], v[152:155], v[92:107]
  s_add_u32 s45, s44, 20480
  buffer_load_dwordx4 v[172:175], v2, s[24:27], s45 offen offset:0 sc1
  v_exp_f32 v116, v116
  v_exp_f32 v117, v117
  v_exp_f32 v118, v118
  v_exp_f32 v119, v119
  v_cvt_pk_bf16_f32 v142, v112, v113
  v_cvt_pk_bf16_f32 v143, v114, v115
  v_exp_f32 v120, v120
  v_exp_f32 v121, v121
  v_mfma_f32_32x32x16_bf16 v[44:59], v[196:199], v[140:143], v[44:59]
  v_exp_f32 v122, v122
  v_exp_f32 v123, v123
  v_cvt_pk_bf16_f32 v144, v116, v117
  v_cvt_pk_bf16_f32 v145, v118, v119
  v_cvt_pk_bf16_f32 v146, v120, v121
  v_cvt_pk_bf16_f32 v147, v122, v123
  v_mfma_f32_32x32x16_bf16 v[108:123], v[188:191], v[28:31], 0
  v_exp_f32 v124, v124
  v_exp_f32 v125, v125
  v_exp_f32 v126, v126
  v_exp_f32 v127, v127
  v_mfma_f32_32x32x16_bf16 v[108:123], v[192:195], v[32:35], v[108:123]
  v_exp_f32 v128, v128
  v_exp_f32 v129, v129
  v_exp_f32 v130, v130
  v_exp_f32 v131, v131
  v_cvt_pk_bf16_f32 v148, v124, v125
  v_cvt_pk_bf16_f32 v149, v126, v127
  v_mfma_f32_32x32x16_bf16 v[44:59], v[200:203], v[144:147], v[44:59]
  buffer_load_dwordx4 v[176:179], v2, s[24:27], s45 offen offset:1024 sc1
  v_exp_f32 v132, v132
  v_exp_f32 v133, v133
  v_exp_f32 v134, v134
  v_exp_f32 v135, v135
  v_cvt_pk_bf16_f32 v150, v128, v129
  v_cvt_pk_bf16_f32 v151, v130, v131
  v_exp_f32 v136, v136
  v_exp_f32 v137, v137
  v_mfma_f32_32x32x16_bf16 v[60:75], v[196:199], v[148:151], v[60:75]
  buffer_load_dword v221, v220, s[24:27], s48 offen sc1
  v_exp_f32 v138, v138
  v_exp_f32 v139, v139
  v_cvt_pk_bf16_f32 v152, v132, v133
  v_cvt_pk_bf16_f32 v153, v134, v135
  v_cvt_pk_bf16_f32 v154, v136, v137
  v_cvt_pk_bf16_f32 v155, v138, v139
  v_mfma_f32_32x32x16_bf16 v[124:139], v[188:191], v[36:39], 0
  v_exp_f32 v108, v108
  v_exp_f32 v109, v109
  v_exp_f32 v110, v110
  v_exp_f32 v111, v111
  v_mfma_f32_32x32x16_bf16 v[124:139], v[192:195], v[40:43], v[124:139]
  v_exp_f32 v112, v112
  v_exp_f32 v113, v113
  v_exp_f32 v114, v114
  v_exp_f32 v115, v115
  v_cvt_pk_bf16_f32 v140, v108, v109
  v_cvt_pk_bf16_f32 v141, v110, v111
  v_mfma_f32_32x32x16_bf16 v[60:75], v[200:203], v[152:155], v[60:75]
  buffer_load_dwordx4 v[180:183], v2, s[24:27], s45 offen offset:2048 sc1
  v_exp_f32 v116, v116
  v_exp_f32 v117, v117
  v_exp_f32 v118, v118
  v_exp_f32 v119, v119
  v_cvt_pk_bf16_f32 v142, v112, v113
  v_cvt_pk_bf16_f32 v143, v114, v115
  v_exp_f32 v120, v120
  v_exp_f32 v121, v121
  v_mfma_f32_32x32x16_bf16 v[76:91], v[196:199], v[140:143], v[76:91]
  v_exp_f32 v122, v122
  v_exp_f32 v123, v123
  v_cvt_pk_bf16_f32 v144, v116, v117
  v_cvt_pk_bf16_f32 v145, v118, v119
  v_cvt_pk_bf16_f32 v146, v120, v121
  v_cvt_pk_bf16_f32 v147, v122, v123
  s_waitcnt vmcnt(8)
  v_mfma_f32_32x32x16_bf16 v[108:123], v[204:207], v[12:15], 0
  v_exp_f32 v124, v124
  v_exp_f32 v125, v125
  v_exp_f32 v126, v126
  v_exp_f32 v127, v127
  v_mfma_f32_32x32x16_bf16 v[108:123], v[208:211], v[16:19], v[108:123]
  v_exp_f32 v128, v128
  v_exp_f32 v129, v129
  v_exp_f32 v130, v130
  v_exp_f32 v131, v131
  v_cvt_pk_bf16_f32 v148, v124, v125
  v_cvt_pk_bf16_f32 v149, v126, v127
  v_mfma_f32_32x32x16_bf16 v[76:91], v[200:203], v[144:147], v[76:91]
  buffer_load_dwordx4 v[184:187], v2, s[24:27], s45 offen offset:3072 sc1
  v_exp_f32 v132, v132
  v_exp_f32 v133, v133
  v_exp_f32 v134, v134
  v_exp_f32 v135, v135
  v_cvt_pk_bf16_f32 v150, v128, v129
  v_cvt_pk_bf16_f32 v151, v130, v131
  v_exp_f32 v136, v136
  v_exp_f32 v137, v137
  v_mfma_f32_32x32x16_bf16 v[92:107], v[196:199], v[148:151], v[92:107]
  v_exp_f32 v138, v138
  v_exp_f32 v139, v139
  v_cvt_pk_bf16_f32 v152, v132, v133
  v_cvt_pk_bf16_f32 v153, v134, v135
  v_cvt_pk_bf16_f32 v154, v136, v137
  v_cvt_pk_bf16_f32 v155, v138, v139
  v_mfma_f32_32x32x16_bf16 v[124:139], v[204:207], v[20:23], 0
  v_exp_f32 v108, v108
  v_exp_f32 v109, v109
  v_exp_f32 v110, v110
  v_exp_f32 v111, v111
  v_mfma_f32_32x32x16_bf16 v[124:139], v[208:211], v[24:27], v[124:139]
  v_exp_f32 v112, v112
  v_exp_f32 v113, v113
  v_exp_f32 v114, v114
  v_exp_f32 v115, v115
  v_cvt_pk_bf16_f32 v140, v108, v109
  v_cvt_pk_bf16_f32 v141, v110, v111
  v_mfma_f32_32x32x16_bf16 v[92:107], v[200:203], v[152:155], v[92:107]
  s_add_u32 s45, s44, 24576
  buffer_load_dwordx4 v[188:191], v2, s[24:27], s45 offen offset:0 sc1
  v_exp_f32 v116, v116
  v_exp_f32 v117, v117
  v_exp_f32 v118, v118
  v_exp_f32 v119, v119
  v_cvt_pk_bf16_f32 v142, v112, v113
  v_cvt_pk_bf16_f32 v143, v114, v115
  v_exp_f32 v120, v120
  v_exp_f32 v121, v121
  v_mfma_f32_32x32x16_bf16 v[44:59], v[212:215], v[140:143], v[44:59]
  v_exp_f32 v122, v122
  v_exp_f32 v123, v123
  v_cvt_pk_bf16_f32 v144, v116, v117
  v_cvt_pk_bf16_f32 v145, v118, v119
  v_cvt_pk_bf16_f32 v146, v120, v121
  v_cvt_pk_bf16_f32 v147, v122, v123
  v_mfma_f32_32x32x16_bf16 v[108:123], v[204:207], v[28:31], 0
  v_exp_f32 v124, v124
  v_exp_f32 v125, v125
  v_exp_f32 v126, v126
  v_exp_f32 v127, v127
  v_mfma_f32_32x32x16_bf16 v[108:123], v[208:211], v[32:35], v[108:123]
  v_exp_f32 v128, v128
  v_exp_f32 v129, v129
  v_exp_f32 v130, v130
  v_exp_f32 v131, v131
  v_cvt_pk_bf16_f32 v148, v124, v125
  v_cvt_pk_bf16_f32 v149, v126, v127
  v_mfma_f32_32x32x16_bf16 v[44:59], v[216:219], v[144:147], v[44:59]
  buffer_load_dwordx4 v[192:195], v2, s[24:27], s45 offen offset:1024 sc1
  v_exp_f32 v132, v132
  v_exp_f32 v133, v133
  v_exp_f32 v134, v134
  v_exp_f32 v135, v135
  v_cvt_pk_bf16_f32 v150, v128, v129
  v_cvt_pk_bf16_f32 v151, v130, v131
  v_exp_f32 v136, v136
  v_exp_f32 v137, v137
  v_mfma_f32_32x32x16_bf16 v[60:75], v[212:215], v[148:151], v[60:75]
  s_waitcnt vmcnt(4)
  s_mov_b32 s5, 0x8000
  s_branch wallc
wall:
  buffer_load_dword v221, v220, s[24:27], s48 offen sc1
  s_waitcnt vmcnt(0)
wallc:
  v_cmp_gt_u32 vcc, 16, v221
  s_sub_u32 s5, s5, 1
  s_cbranch_scc1 walld
  s_cbranch_vccnz wall
walld:
  v_exp_f32 v138, v138
  v_exp_f32 v139, v139
  v_cvt_pk_bf16_f32 v152, v132, v133
  v_cvt_pk_bf16_f32 v153, v134, v135
  v_cvt_pk_bf16_f32 v154, v136, v137
  v_cvt_pk_bf16_f32 v155, v138, v139
  v_mfma_f32_32x32x16_bf16 v[124:139], v[204:207], v[36:39], 0
  v_exp_f32 v108, v108
  v_exp_f32 v109, v109
  v_exp_f32 v110, v110
  v_exp_f32 v111, v111
  v_mfma_f32_32x32x16_bf16 v[124:139], v[208:211], v[40:43], v[124:139]
  v_exp_f32 v112, v112
  v_exp_f32 v113, v113
  v_exp_f32 v114, v114
  v_exp_f32 v115, v115
  v_cvt_pk_bf16_f32 v140, v108, v109
  v_cvt_pk_bf16_f32 v141, v110, v111
  v_mfma_f32_32x32x16_bf16 v[60:75], v[216:219], v[152:155], v[60:75]
  buffer_load_dwordx4 v[196:199], v2, s[24:27], s45 offen offset:2048 sc1
  v_exp_f32 v116, v116
  v_exp_f32 v117, v117
  v_exp_f32 v118, v118
  v_exp_f32 v119, v119
  v_cvt_pk_bf16_f32 v142, v112, v113
  v_cvt_pk_bf16_f32 v143, v114, v115
  v_exp_f32 v120, v120
  v_exp_f32 v121, v121
  v_mfma_f32_32x32x16_bf16 v[76:91], v[212:215], v[140:143], v[76:91]
  buffer_load_dwordx4 a[192:195], v2, s[24:27], s50 offen offset:0 sc1
  v_exp_f32 v122, v122
  v_exp_f32 v123, v123
  v_cvt_pk_bf16_f32 v144, v116, v117
  v_cvt_pk_bf16_f32 v145, v118, v119
  v_cvt_pk_bf16_f32 v146, v120, v121
  v_cvt_pk_bf16_f32 v147, v122, v123
  v_mfma_f32_32x32x16_bf16 v[108:123], v[156:159], v[12:15], 0
  v_exp_f32 v124, v124
  v_exp_f32 v125, v125
  v_exp_f32 v126, v126
  v_exp_f32 v127, v127
  v_mfma_f32_32x32x16_bf16 v[108:123], v[160:163], v[16:19], v[108:123]
  v_exp_f32 v128, v128
  v_exp_f32 v129, v129
  v_exp_f32 v130, v130
  v_exp_f32 v131, v131
  v_cvt_pk_bf16_f32 v148, v124, v125
  v_cvt_pk_bf16_f32 v149, v126, v127
  v_mfma_f32_32x32x16_bf16 v[76:91], v[216:219], v[144:147], v[76:91]
  buffer_load_dwordx4 v[200:203], v2, s[24:27], s45 offen offset:3072 sc1
  v_exp_f32 v132, v132
  v_exp_f32 v133, v133
  v_exp_f32 v134, v134
  v_exp_f32 v135, v135
  v_cvt_pk_bf16_f32 v150, v128, v129
  v_cvt_pk_bf16_f32 v151, v130, v131
  v_exp_f32 v136, v136
  v_exp_f32 v137, v137
  v_mfma_f32_32x32x16_bf16 v[92:107], v[212:215], v[148:151], v[92:107]
  buffer_load_dwordx4 a[196:199], v2, s[24:27], s51 offen offset:0 sc1
  v_exp_f32 v138, v138
  v_exp_f32 v139, v139
  v_cvt_pk_bf16_f32 v152, v132, v133
  v_cvt_pk_bf16_f32 v153, v134, v135
  v_cvt_pk_bf16_f32 v154, v136, v137
  v_cvt_pk_bf16_f32 v155, v138, v139
  v_mfma_f32_32x32x16_bf16 v[124:139], v[156:159], v[20:23], 0
  v_exp_f32 v108, v108
  v_exp_f32 v109, v109
  v_exp_f32 v110, v110
  v_exp_f32 v111, v111
  v_mfma_f32_32x32x16_bf16 v[124:139], v[160:163], v[24:27], v[124:139]
  v_exp_f32 v112, v112
  v_exp_f32 v113, v113
  v_exp_f32 v114, v114
  v_exp_f32 v115, v115
  v_cvt_pk_bf16_f32 v140, v108, v109
  v_cvt_pk_bf16_f32 v141, v110, v111
  v_mfma_f32_32x32x16_bf16 v[92:107], v[216:219], v[152:155], v[92:107]
  s_add_u32 s45, s44, 28672
  buffer_load_dwordx4 v[204:207], v2, s[24:27], s45 offen offset:0 sc1
  v_exp_f32 v116, v116
  v_exp_f32 v117, v117
  v_exp_f32 v118, v118
  v_exp_f32 v119, v119
  v_cvt_pk_bf16_f32 v142, v112, v113
  v_cvt_pk_bf16_f32 v143, v114, v115
  v_exp_f32 v120, v120
  v_exp_f32 v121, v121
  v_mfma_f32_32x32x16_bf16 v[44:59], v[164:167], v[140:143], v[44:59]
  buffer_load_dwordx4 a[200:203], v2, s[24:27], s50 offen offset:1024 sc1
  v_exp_f32 v122, v122
  v_exp_f32 v123, v123
  v_cvt_pk_bf16_f32 v144, v116, v117
  v_cvt_pk_bf16_f32 v145, v118, v119
  v_cvt_pk_bf16_f32 v146, v120, v121
  v_cvt_pk_bf16_f32 v147, v122, v123
  v_mfma_f32_32x32x16_bf16 v[108:123], v[156:159], v[28:31], 0
  v_exp_f32 v124, v124
  v_exp_f32 v125, v125
  v_exp_f32 v126, v126
  v_exp_f32 v127, v127
  v_mfma_f32_32x32x16_bf16 v[108:123], v[160:163], v[32:35], v[108:123]
  v_exp_f32 v128, v128
  v_exp_f32 v129, v129
  v_exp_f32 v130, v130
  v_exp_f32 v131, v131
  v_cvt_pk_bf16_f32 v148, v124, v125
  v_cvt_pk_bf16_f32 v149, v126, v127
  v_mfma_f32_32x32x16_bf16 v[44:59], v[168:171], v[144:147], v[44:59]
  buffer_load_dwordx4 v[208:211], v2, s[24:27], s45 offen offset:1024 sc1
  v_exp_f32 v132, v132
  v_exp_f32 v133, v133
  v_exp_f32 v134, v134
  v_exp_f32 v135, v135
  v_cvt_pk_bf16_f32 v150, v128, v129
  v_cvt_pk_bf16_f32 v151, v130, v131
  v_exp_f32 v136, v136
  v_exp_f32 v137, v137
  v_mfma_f32_32x32x16_bf16 v[60:75], v[164:167], v[148:151], v[60:75]
  buffer_load_dwordx4 a[204:207], v2, s[24:27], s51 offen offset:1024 sc1
  buffer_load_dwordx4 a[208:211], v2, s[24:27], s50 offen offset:2048 sc1
  v_exp_f32 v138, v138
  v_exp_f32 v139, v139
  v_cvt_pk_bf16_f32 v152, v132, v133
  v_cvt_pk_bf16_f32 v153, v134, v135
  v_cvt_pk_bf16_f32 v154, v136, v137
  v_cvt_pk_bf16_f32 v155, v138, v139
  v_mfma_f32_32x32x16_bf16 v[124:139], v[156:159], v[36:39], 0
  v_exp_f32 v108, v108
  v_exp_f32 v109, v109
  v_exp_f32 v110, v110
  v_exp_f32 v111, v111
  v_mfma_f32_32x32x16_bf16 v[124:139], v[160:163], v[40:43], v[124:139]
  v_exp_f32 v112, v112
  v_exp_f32 v113, v113
  v_exp_f32 v114, v114
  v_exp_f32 v115, v115
  v_cvt_pk_bf16_f32 v140, v108, v109
  v_cvt_pk_bf16_f32 v141, v110, v111
  v_mfma_f32_32x32x16_bf16 v[60:75], v[168:171], v[152:155], v[60:75]
  buffer_load_dwordx4 v[212:215], v2, s[24:27], s45 offen offset:2048 sc1
  v_exp_f32 v116, v116
  v_exp_f32 v117, v117
  v_exp_f32 v118, v118
  v_exp_f32 v119, v119
  v_cvt_pk_bf16_f32 v142, v112, v113
  v_cvt_pk_bf16_f32 v143, v114, v115
  v_exp_f32 v120, v120
  v_exp_f32 v121, v121
  v_mfma_f32_32x32x16_bf16 v[76:91], v[164:167], v[140:143], v[76:91]
  buffer_load_dwordx4 a[212:215], v2, s[24:27], s51 offen offset:2048 sc1
  v_exp_f32 v122, v122
  v_exp_f32 v123, v123
  v_cvt_pk_bf16_f32 v144, v116, v117
  v_cvt_pk_bf16_f32 v145, v118, v119
  v_cvt_pk_bf16_f32 v146, v120, v121
  v_cvt_pk_bf16_f32 v147, v122, v123
  s_waitcnt vmcnt(13)
  v_mfma_f32_32x32x16_bf16 v[108:123], v[172:175], v[12:15], 0
  v_exp_f32 v124, v124
  v_exp_f32 v125, v125
  v_exp_f32 v126, v126
  v_exp_f32 v127, v127
  v_mfma_f32_32x32x16_bf16 v[108:123], v[176:179], v[16:19], v[108:123]
  v_exp_f32 v128, v128
  v_exp_f32 v129, v129
  v_exp_f32 v130, v130
  v_exp_f32 v131, v131
  v_cvt_pk_bf16_f32 v148, v124, v125
  v_cvt_pk_bf16_f32 v149, v126, v127
  v_mfma_f32_32x32x16_bf16 v[76:91], v[168:171], v[144:147], v[76:91]
  buffer_load_dwordx4 v[216:219], v2, s[24:27], s45 offen offset:3072 sc1
  v_exp_f32 v132, v132
  v_exp_f32 v133, v133
  v_exp_f32 v134, v134
  v_exp_f32 v135, v135
  v_cvt_pk_bf16_f32 v150, v128, v129
  v_cvt_pk_bf16_f32 v151, v130, v131
  v_exp_f32 v136, v136
  v_exp_f32 v137, v137
  v_mfma_f32_32x32x16_bf16 v[92:107], v[164:167], v[148:151], v[92:107]
  buffer_load_dwordx4 a[216:219], v2, s[24:27], s50 offen offset:3072 sc1
  v_exp_f32 v138, v138
  v_exp_f32 v139, v139
  v_cvt_pk_bf16_f32 v152, v132, v133
  v_cvt_pk_bf16_f32 v153, v134, v135
  v_cvt_pk_bf16_f32 v154, v136, v137
  v_cvt_pk_bf16_f32 v155, v138, v139
  v_mfma_f32_32x32x16_bf16 v[124:139], v[172:175], v[20:23], 0
  v_exp_f32 v108, v108
  v_exp_f32 v109, v109
  v_exp_f32 v110, v110
  v_exp_f32 v111, v111
  v_mfma_f32_32x32x16_bf16 v[124:139], v[176:179], v[24:27], v[124:139]
  v_exp_f32 v112, v112
  v_exp_f32 v113, v113
  v_exp_f32 v114, v114
  v_exp_f32 v115, v115
  v_cvt_pk_bf16_f32 v140, v108, v109
  v_cvt_pk_bf16_f32 v141, v110, v111
  v_mfma_f32_32x32x16_bf16 v[92:107], v[168:171], v[152:155], v[92:107]
  s_add_u32 s45, s44, 32768
  buffer_load_dwordx4 v[156:159], v2, s[24:27], s45 offen offset:0 sc1
  v_exp_f32 v116, v116
  v_exp_f32 v117, v117
  v_exp_f32 v118, v118
  v_exp_f32 v119, v119
  v_cvt_pk_bf16_f32 v142, v112, v113
  v_cvt_pk_bf16_f32 v143, v114, v115
  v_exp_f32 v120, v120
  v_exp_f32 v121, v121
  v_mfma_f32_32x32x16_bf16 v[44:59], v[180:183], v[140:143], v[44:59]
  buffer_load_dwordx4 a[220:223], v2, s[24:27], s51 offen offset:3072 sc1
  v_exp_f32 v122, v122
  v_exp_f32 v123, v123
  v_cvt_pk_bf16_f32 v144, v116, v117
  v_cvt_pk_bf16_f32 v145, v118, v119
  v_cvt_pk_bf16_f32 v146, v120, v121
  v_cvt_pk_bf16_f32 v147, v122, v123
  v_mfma_f32_32x32x16_bf16 v[108:123], v[172:175], v[28:31], 0
  v_exp_f32 v124, v124
  v_exp_f32 v125, v125
  v_exp_f32 v126, v126
  v_exp_f32 v127, v127
  v_mfma_f32_32x32x16_bf16 v[108:123], v[176:179], v[32:35], v[108:123]
  v_exp_f32 v128, v128
  v_exp_f32 v129, v129
  v_exp_f32 v130, v130
  v_exp_f32 v131, v131
  v_cvt_pk_bf16_f32 v148, v124, v125
  v_cvt_pk_bf16_f32 v149, v126, v127
  v_mfma_f32_32x32x16_bf16 v[44:59], v[184:187], v[144:147], v[44:59]
  buffer_load_dwordx4 v[160:163], v2, s[24:27], s45 offen offset:1024 sc1
  v_exp_f32 v132, v132
  v_exp_f32 v133, v133
  v_exp_f32 v134, v134
  v_exp_f32 v135, v135
  v_cvt_pk_bf16_f32 v150, v128, v129
  v_cvt_pk_bf16_f32 v151, v130, v131
  v_exp_f32 v136, v136
  v_exp_f32 v137, v137
  v_mfma_f32_32x32x16_bf16 v[60:75], v[180:183], v[148:151], v[60:75]
  s_add_u32 s50, s50, 4096
  s_add_u32 s51, s51, 4096
  buffer_load_dwordx4 a[224:227], v2, s[24:27], s50 offen offset:0 sc1
  buffer_load_dwordx4 a[228:231], v2, s[24:27], s51 offen offset:0 sc1
  v_exp_f32 v138, v138
  v_exp_f32 v139, v139
  v_cvt_pk_bf16_f32 v152, v132, v133
  v_cvt_pk_bf16_f32 v153, v134, v135
  v_cvt_pk_bf16_f32 v154, v136, v137
  v_cvt_pk_bf16_f32 v155, v138, v139
  v_mfma_f32_32x32x16_bf16 v[124:139], v[172:175], v[36:39], 0
  v_exp_f32 v108, v108
  v_exp_f32 v109, v109
  v_exp_f32 v110, v110
  v_exp_f32 v111, v111
  v_mfma_f32_32x32x16_bf16 v[124:139], v[176:179], v[40:43], v[124:139]
  v_exp_f32 v112, v112
  v_exp_f32 v113, v113
  v_exp_f32 v114, v114
  v_exp_f32 v115, v115
  v_cvt_pk_bf16_f32 v140, v108, v109
  v_cvt_pk_bf16_f32 v141, v110, v111
  v_mfma_f32_32x32x16_bf16 v[60:75], v[184:187], v[152:155], v[60:75]
  buffer_load_dwordx4 v[164:167], v2, s[24:27], s45 offen offset:2048 sc1
  v_exp_f32 v116, v116
  v_exp_f32 v117, v117
  v_exp_f32 v118, v118
  v_exp_f32 v119, v119
  v_cvt_pk_bf16_f32 v142, v112, v113
  v_cvt_pk_bf16_f32 v143, v114, v115
  v_exp_f32 v120, v120
  v_exp_f32 v121, v121
  v_mfma_f32_32x32x16_bf16 v[76:91], v[180:183], v[140:143], v[76:91]
  buffer_load_dwordx4 a[232:235], v2, s[24:27], s50 offen offset:1024 sc1
  v_exp_f32 v122, v122
  v_exp_f32 v123, v123
  v_cvt_pk_bf16_f32 v144, v116, v117
  v_cvt_pk_bf16_f32 v145, v118, v119
  v_cvt_pk_bf16_f32 v146, v120, v121
  v_cvt_pk_bf16_f32 v147, v122, v123
  s_waitcnt vmcnt(17)
  v_mfma_f32_32x32x16_bf16 v[108:123], v[188:191], v[12:15], 0
  v_exp_f32 v124, v124
  v_exp_f32 v125, v125
  v_exp_f32 v126, v126
  v_exp_f32 v127, v127
  v_mfma_f32_32x32x16_bf16 v[108:123], v[192:195], v[16:19], v[108:123]
  v_exp_f32 v128, v128
  v_exp_f32 v129, v129
  v_exp_f32 v130, v130
  v_exp_f32 v131, v131
  v_cvt_pk_bf16_f32 v148, v124, v125
  v_cvt_pk_bf16_f32 v149, v126, v127
  v_mfma_f32_32x32x16_bf16 v[76:91], v[184:187], v[144:147], v[76:91]
  buffer_load_dwordx4 v[168:171], v2, s[24:27], s45 offen offset:3072 sc1
  v_exp_f32 v132, v132
  v_exp_f32 v133, v133
  v_exp_f32 v134, v134
  v_exp_f32 v135, v135
  v_cvt_pk_bf16_f32 v150, v128, v129
  v_cvt_pk_bf16_f32 v151, v130, v131
  v_exp_f32 v136, v136
  v_exp_f32 v137, v137
  v_mfma_f32_32x32x16_bf16 v[92:107], v[180:183], v[148:151], v[92:107]
  buffer_load_dwordx4 a[236:239], v2, s[24:27], s51 offen offset:1024 sc1
  v_exp_f32 v138, v138
  v_exp_f32 v139, v139
  v_cvt_pk_bf16_f32 v152, v132, v133
  v_cvt_pk_bf16_f32 v153, v134, v135
  v_cvt_pk_bf16_f32 v154, v136, v137
  v_cvt_pk_bf16_f32 v155, v138, v139
  v_mfma_f32_32x32x16_bf16 v[124:139], v[188:191], v[20:23], 0
  v_exp_f32 v108, v108
  v_exp_f32 v109, v109
  v_exp_f32 v110, v110
  v_exp_f32 v111, v111
  v_mfma_f32_32x32x16_bf16 v[124:139], v[192:195], v[24:27], v[124:139]
  v_exp_f32 v112, v112
  v_exp_f32 v113, v113
  v_exp_f32 v114, v114
  v_exp_f32 v115, v115
  v_cvt_pk_bf16_f32 v140, v108, v109
  v_cvt_pk_bf16_f32 v141, v110, v111
  v_mfma_f32_32x32x16_bf16 v[92:107], v[184:187], v[152:155], v[92:107]
  s_add_u32 s45, s44, 36864
  buffer_load_dwordx4 v[172:175], v2, s[24:27], s45 offen offset:0 sc1
  v_exp_f32 v116, v116
  v_exp_f32 v117, v117
  v_exp_f32 v118, v118
  v_exp_f32 v119, v119
  v_cvt_pk_bf16_f32 v142, v112, v113
  v_cvt_pk_bf16_f32 v143, v114, v115
  v_exp_f32 v120, v120
  v_exp_f32 v121, v121
  v_mfma_f32_32x32x16_bf16 v[44:59], v[196:199], v[140:143], v[44:59]
  buffer_load_dwordx4 a[240:243], v2, s[24:27], s50 offen offset:2048 sc1
  buffer_load_dwordx4 a[244:247], v2, s[24:27], s51 offen offset:2048 sc1
  v_exp_f32 v122, v122
  v_exp_f32 v123, v123
  v_cvt_pk_bf16_f32 v144, v116, v117
  v_cvt_pk_bf16_f32 v145, v118, v119
  v_cvt_pk_bf16_f32 v146, v120, v121
  v_cvt_pk_bf16_f32 v147, v122, v123
  v_mfma_f32_32x32x16_bf16 v[108:123], v[188:191], v[28:31], 0
  v_exp_f32 v124, v124
  v_exp_f32 v125, v125
  v_exp_f32 v126, v126
  v_exp_f32 v127, v127
  v_mfma_f32_32x32x16_bf16 v[108:123], v[192:195], v[32:35], v[108:123]
  v_exp_f32 v128, v128
  v_exp_f32 v129, v129
  v_exp_f32 v130, v130
  v_exp_f32 v131, v131
  v_cvt_pk_bf16_f32 v148, v124, v125
  v_cvt_pk_bf16_f32 v149, v126, v127
  v_mfma_f32_32x32x16_bf16 v[44:59], v[200:203], v[144:147], v[44:59]
  buffer_load_dwordx4 v[176:179], v2, s[24:27], s45 offen offset:1024 sc1
  v_exp_f32 v132, v132
  v_exp_f32 v133, v133
  v_exp_f32 v134, v134
  v_exp_f32 v135, v135
  v_cvt_pk_bf16_f32 v150, v128, v129
  v_cvt_pk_bf16_f32 v151, v130, v131
  v_exp_f32 v136, v136
  v_exp_f32 v137, v137
  v_mfma_f32_32x32x16_bf16 v[60:75], v[196:199], v[148:151], v[60:75]
  buffer_load_dwordx4 a[248:251], v2, s[24:27], s50 offen offset:3072 sc1
  v_exp_f32 v138, v138
  v_exp_f32 v139, v139
  v_cvt_pk_bf16_f32 v152, v132, v133
  v_cvt_pk_bf16_f32 v153, v134, v135
  v_cvt_pk_bf16_f32 v154, v136, v137
  v_cvt_pk_bf16_f32 v155, v138, v139
  v_mfma_f32_32x32x16_bf16 v[124:139], v[188:191], v[36:39], 0
  v_exp_f32 v108, v108
  v_exp_f32 v109, v109
  v_exp_f32 v110, v110
  v_exp_f32 v111, v111
  v_mfma_f32_32x32x16_bf16 v[124:139], v[192:195], v[40:43], v[124:139]
  v_exp_f32 v112, v112
  v_exp_f32 v113, v113
  v_exp_f32 v114, v114
  v_exp_f32 v115, v115
  v_cvt_pk_bf16_f32 v140, v108, v109
  v_cvt_pk_bf16_f32 v141, v110, v111
  v_mfma_f32_32x32x16_bf16 v[60:75], v[200:203], v[152:155], v[60:75]
  buffer_load_dwordx4 v[180:183], v2, s[24:27], s45 offen offset:2048 sc1
  v_exp_f32 v116, v116
  v_exp_f32 v117, v117
  v_exp_f32 v118, v118
  v_exp_f32 v119, v119
  v_cvt_pk_bf16_f32 v142, v112, v113
  v_cvt_pk_bf16_f32 v143, v114, v115
  v_exp_f32 v120, v120
  v_exp_f32 v121, v121
  v_mfma_f32_32x32x16_bf16 v[76:91], v[196:199], v[140:143], v[76:91]
  buffer_load_dwordx4 a[252:255], v2, s[24:27], s51 offen offset:3072 sc1
  v_exp_f32 v122, v122
  v_exp_f32 v123, v123
  v_cvt_pk_bf16_f32 v144, v116, v117
  v_cvt_pk_bf16_f32 v145, v118, v119
  v_cvt_pk_bf16_f32 v146, v120, v121
  v_cvt_pk_bf16_f32 v147, v122, v123
  s_waitcnt vmcnt(17)
  v_mfma_f32_32x32x16_bf16 v[108:123], v[204:207], v[12:15], 0
  v_exp_f32 v124, v124
  v_exp_f32 v125, v125
  v_exp_f32 v126, v126
  v_exp_f32 v127, v127
  v_mfma_f32_32x32x16_bf16 v[108:123], v[208:211], v[16:19], v[108:123]
  v_exp_f32 v128, v128
  v_exp_f32 v129, v129
  v_exp_f32 v130, v130
  v_exp_f32 v131, v131
  v_cvt_pk_bf16_f32 v148, v124, v125
  v_cvt_pk_bf16_f32 v149, v126, v127
  v_mfma_f32_32x32x16_bf16 v[76:91], v[200:203], v[144:147], v[76:91]
  buffer_load_dwordx4 v[184:187], v2, s[24:27], s45 offen offset:3072 sc1
  v_exp_f32 v132, v132
  v_exp_f32 v133, v133
  v_exp_f32 v134, v134
  v_exp_f32 v135, v135
  v_cvt_pk_bf16_f32 v150, v128, v129
  v_cvt_pk_bf16_f32 v151, v130, v131
  v_exp_f32 v136, v136
  v_exp_f32 v137, v137
  v_mfma_f32_32x32x16_bf16 v[92:107], v[196:199], v[148:151], v[92:107]
  s_add_u32 s46, s53, 0
  buffer_load_dwordx4 a[0:3], v2, s[24:27], s46 offen offset:0 sc1
  v_exp_f32 v138, v138
  v_exp_f32 v139, v139
  v_cvt_pk_bf16_f32 v152, v132, v133
  v_cvt_pk_bf16_f32 v153, v134, v135
  v_cvt_pk_bf16_f32 v154, v136, v137
  v_cvt_pk_bf16_f32 v155, v138, v139
  v_mfma_f32_32x32x16_bf16 v[124:139], v[204:207], v[20:23], 0
  v_exp_f32 v108, v108
  v_exp_f32 v109, v109
  v_exp_f32 v110, v110
  v_exp_f32 v111, v111
  v_mfma_f32_32x32x16_bf16 v[124:139], v[208:211], v[24:27], v[124:139]
  v_exp_f32 v112, v112
  v_exp_f32 v113, v113
  v_exp_f32 v114, v114
  v_exp_f32 v115, v115
  v_cvt_pk_bf16_f32 v140, v108, v109
  v_cvt_pk_bf16_f32 v141, v110, v111
  v_mfma_f32_32x32x16_bf16 v[92:107], v[200:203], v[152:155], v[92:107]
  s_add_u32 s45, s44, 40960
  buffer_load_dwordx4 v[188:191], v2, s[24:27], s45 offen offset:0 sc1
  v_exp_f32 v116, v116
  v_exp_f32 v117, v117
  v_exp_f32 v118, v118
  v_exp_f32 v119, v119
  v_cvt_pk_bf16_f32 v142, v112, v113
  v_cvt_pk_bf16_f32 v143, v114, v115
  v_exp_f32 v120, v120
  v_exp_f32 v121, v121
  v_mfma_f32_32x32x16_bf16 v[44:59], v[212:215], v[140:143], v[44:59]
  buffer_load_dwordx4 a[4:7], v2, s[24:27], s46 offen offset:1024 sc1
  buffer_load_dwordx4 a[8:11], v2, s[24:27], s46 offen offset:2048 sc1
  v_exp_f32 v122, v122
  v_exp_f32 v123, v123
  v_cvt_pk_bf16_f32 v144, v116, v117
  v_cvt_pk_bf16_f32 v145, v118, v119
  v_cvt_pk_bf16_f32 v146, v120, v121
  v_cvt_pk_bf16_f32 v147, v122, v123
  v_mfma_f32_32x32x16_bf16 v[108:123], v[204:207], v[28:31], 0
  v_exp_f32 v124, v124
  v_exp_f32 v125, v125
  v_exp_f32 v126, v126
  v_exp_f32 v127, v127
  v_mfma_f32_32x32x16_bf16 v[108:123], v[208:211], v[32:35], v[108:123]
  v_exp_f32 v128, v128
  v_exp_f32 v129, v129
  v_exp_f32 v130, v130
  v_exp_f32 v131, v131
  v_cvt_pk_bf16_f32 v148, v124, v125
  v_cvt_pk_bf16_f32 v149, v126, v127
  v_mfma_f32_32x32x16_bf16 v[44:59], v[216:219], v[144:147], v[44:59]
  buffer_load_dwordx4 v[192:195], v2, s[24:27], s45 offen offset:1024 sc1
  v_exp_f32 v132, v132
  v_exp_f32 v133, v133
  v_exp_f32 v134, v134
  v_exp_f32 v135, v135
  v_cvt_pk_bf16_f32 v150, v128, v129
  v_cvt_pk_bf16_f32 v151, v130, v131
  v_exp_f32 v136, v136
  v_exp_f32 v137, v137
  v_mfma_f32_32x32x16_bf16 v[60:75], v[212:215], v[148:151], v[60:75]
  buffer_load_dwordx4 a[12:15], v2, s[24:27], s46 offen offset:3072 sc1
  v_exp_f32 v138, v138
  v_exp_f32 v139, v139
  v_cvt_pk_bf16_f32 v152, v132, v133
  v_cvt_pk_bf16_f32 v153, v134, v135
  v_cvt_pk_bf16_f32 v154, v136, v137
  v_cvt_pk_bf16_f32 v155, v138, v139
  v_mfma_f32_32x32x16_bf16 v[124:139], v[204:207], v[36:39], 0
  v_exp_f32 v108, v108
  v_exp_f32 v109, v109
  v_exp_f32 v110, v110
  v_exp_f32 v111, v111
  v_mfma_f32_32x32x16_bf16 v[124:139], v[208:211], v[40:43], v[124:139]
  v_exp_f32 v112, v112
  v_exp_f32 v113, v113
  v_exp_f32 v114, v114
  v_exp_f32 v115, v115
  v_cvt_pk_bf16_f32 v140, v108, v109
  v_cvt_pk_bf16_f32 v141, v110, v111
  v_mfma_f32_32x32x16_bf16 v[60:75], v[216:219], v[152:155], v[60:75]
  buffer_load_dwordx4 v[196:199], v2, s[24:27], s45 offen offset:2048 sc1
  v_exp_f32 v116, v116
  v_exp_f32 v117, v117
  v_exp_f32 v118, v118
  v_exp_f32 v119, v119
  v_cvt_pk_bf16_f32 v142, v112, v113
  v_cvt_pk_bf16_f32 v143, v114, v115
  v_exp_f32 v120, v120
  v_exp_f32 v121, v121
  v_mfma_f32_32x32x16_bf16 v[76:91], v[212:215], v[140:143], v[76:91]
  s_add_u32 s46, s53, 4096
  buffer_load_dwordx4 a[16:19], v2, s[24:27], s46 offen offset:0 sc1
  v_exp_f32 v122, v122
  v_exp_f32 v123, v123
  v_cvt_pk_bf16_f32 v144, v116, v117
  v_cvt_pk_bf16_f32 v145, v118, v119
  v_cvt_pk_bf16_f32 v146, v120, v121
  v_cvt_pk_bf16_f32 v147, v122, v123
  s_waitcnt vmcnt(17)
  v_mfma_f32_32x32x16_bf16 v[108:123], v[156:159], v[12:15], 0
  v_exp_f32 v124, v124
  v_exp_f32 v125, v125
  v_exp_f32 v126, v126
  v_exp_f32 v127, v127
  v_mfma_f32_32x32x16_bf16 v[108:123], v[160:163], v[16:19], v[108:123]
  v_exp_f32 v128, v128
  v_exp_f32 v129, v129
  v_exp_f32 v130, v130
  v_exp_f32 v131, v131
  v_cvt_pk_bf16_f32 v148, v124, v125
  v_cvt_pk_bf16_f32 v149, v126, v127
  v_mfma_f32_32x32x16_bf16 v[76:91], v[216:219], v[144:147], v[76:91]
  buffer_load_dwordx4 v[200:203], v2, s[24:27], s45 offen offset:3072 sc1
  v_exp_f32 v132, v132
  v_exp_f32 v133, v133
  v_exp_f32 v134, v134
  v_exp_f32 v135, v135
  v_cvt_pk_bf16_f32 v150, v128, v129
  v_cvt_pk_bf16_f32 v151, v130, v131
  v_exp_f32 v136, v136
  v_exp_f32 v137, v137
  v_mfma_f32_32x32x16_bf16 v[92:107], v[212:215], v[148:151], v[92:107]
  buffer_load_dwordx4 a[20:23], v2, s[24:27], s46 offen offset:1024 sc1
  buffer_load_dwordx4 a[24:27], v2, s[24:27], s46 offen offset:2048 sc1
  v_exp_f32 v138, v138
  v_exp_f32 v139, v139
  v_cvt_pk_bf16_f32 v152, v132, v133
  v_cvt_pk_bf16_f32 v153, v134, v135
  v_cvt_pk_bf16_f32 v154, v136, v137
  v_cvt_pk_bf16_f32 v155, v138, v139
  v_mfma_f32_32x32x16_bf16 v[124:139], v[156:159], v[20:23], 0
  v_exp_f32 v108, v108
  v_exp_f32 v109, v109
  v_exp_f32 v110, v110
  v_exp_f32 v111, v111
  v_mfma_f32_32x32x16_bf16 v[124:139], v[160:163], v[24:27], v[124:139]
  v_exp_f32 v112, v112
  v_exp_f32 v113, v113
  v_exp_f32 v114, v114
  v_exp_f32 v115, v115
  v_cvt_pk_bf16_f32 v140, v108, v109
  v_cvt_pk_bf16_f32 v141, v110, v111
  v_mfma_f32_32x32x16_bf16 v[92:107], v[216:219], v[152:155], v[92:107]
  s_add_u32 s45, s44, 45056
  buffer_load_dwordx4 v[204:207], v2, s[24:27], s45 offen offset:0 sc1
  v_exp_f32 v116, v116
  v_exp_f32 v117, v117
  v_exp_f32 v118, v118
  v_exp_f32 v119, v119
  v_cvt_pk_bf16_f32 v142, v112, v113
  v_cvt_pk_bf16_f32 v143, v114, v115
  v_exp_f32 v120, v120
  v_exp_f32 v121, v121
  v_mfma_f32_32x32x16_bf16 v[44:59], v[164:167], v[140:143], v[44:59]
  buffer_load_dwordx4 a[28:31], v2, s[24:27], s46 offen offset:3072 sc1
  v_exp_f32 v122, v122
  v_exp_f32 v123, v123
  v_cvt_pk_bf16_f32 v144, v116, v117
  v_cvt_pk_bf16_f32 v145, v118, v119
  v_cvt_pk_bf16_f32 v146, v120, v121
  v_cvt_pk_bf16_f32 v147, v122, v123
  v_mfma_f32_32x32x16_bf16 v[108:123], v[156:159], v[28:31], 0
  v_exp_f32 v124, v124
  v_exp_f32 v125, v125
  v_exp_f32 v126, v126
  v_exp_f32 v127, v127
  v_mfma_f32_32x32x16_bf16 v[108:123], v[160:163], v[32:35], v[108:123]
  v_exp_f32 v128, v128
  v_exp_f32 v129, v129
  v_exp_f32 v130, v130
  v_exp_f32 v131, v131
  v_cvt_pk_bf16_f32 v148, v124, v125
  v_cvt_pk_bf16_f32 v149, v126, v127
  v_mfma_f32_32x32x16_bf16 v[44:59], v[168:171], v[144:147], v[44:59]
  buffer_load_dwordx4 v[208:211], v2, s[24:27], s45 offen offset:1024 sc1
  v_exp_f32 v132, v132
  v_exp_f32 v133, v133
  v_exp_f32 v134, v134
  v_exp_f32 v135, v135
  v_cvt_pk_bf16_f32 v150, v128, v129
  v_cvt_pk_bf16_f32 v151, v130, v131
  v_exp_f32 v136, v136
  v_exp_f32 v137, v137
  v_mfma_f32_32x32x16_bf16 v[60:75], v[164:167], v[148:151], v[60:75]
  s_add_u32 s46, s53, 8192
  buffer_load_dwordx4 a[32:35], v2, s[24:27], s46 offen offset:0 sc1
  v_exp_f32 v138, v138
  v_exp_f32 v139, v139
  v_cvt_pk_bf16_f32 v152, v132, v133
  v_cvt_pk_bf16_f32 v153, v134, v135
  v_cvt_pk_bf16_f32 v154, v136, v137
  v_cvt_pk_bf16_f32 v155, v138, v139
  v_mfma_f32_32x32x16_bf16 v[124:139], v[156:159], v[36:39], 0
  v_exp_f32 v108, v108
  v_exp_f32 v109, v109
  v_exp_f32 v110, v110
  v_exp_f32 v111, v111
  v_mfma_f32_32x32x16_bf16 v[124:139], v[160:163], v[40:43], v[124:139]
  v_exp_f32 v112, v112
  v_exp_f32 v113, v113
  v_exp_f32 v114, v114
  v_exp_f32 v115, v115
  v_cvt_pk_bf16_f32 v140, v108, v109
  v_cvt_pk_bf16_f32 v141, v110, v111
  v_mfma_f32_32x32x16_bf16 v[60:75], v[168:171], v[152:155], v[60:75]
  buffer_load_dwordx4 v[212:215], v2, s[24:27], s45 offen offset:2048 sc1
  v_exp_f32 v116, v116
  v_exp_f32 v117, v117
  v_exp_f32 v118, v118
  v_exp_f32 v119, v119
  v_cvt_pk_bf16_f32 v142, v112, v113
  v_cvt_pk_bf16_f32 v143, v114, v115
  v_exp_f32 v120, v120
  v_exp_f32 v121, v121
  v_mfma_f32_32x32x16_bf16 v[76:91], v[164:167], v[140:143], v[76:91]
  buffer_load_dwordx4 a[36:39], v2, s[24:27], s46 offen offset:1024 sc1
  v_exp_f32 v122, v122
  v_exp_f32 v123, v123
  v_cvt_pk_bf16_f32 v144, v116, v117
  v_cvt_pk_bf16_f32 v145, v118, v119
  v_cvt_pk_bf16_f32 v146, v120, v121
  v_cvt_pk_bf16_f32 v147, v122, v123
  s_waitcnt vmcnt(17)
  v_mfma_f32_32x32x16_bf16 v[108:123], v[172:175], v[12:15], 0
  v_exp_f32 v124, v124
  v_exp_f32 v125, v125
  v_exp_f32 v126, v126
  v_exp_f32 v127, v127
  v_mfma_f32_32x32x16_bf16 v[108:123], v[176:179], v[16:19], v[108:123]
  v_exp_f32 v128, v128
  v_exp_f32 v129, v129
  v_exp_f32 v130, v130
  v_exp_f32 v131, v131
  v_cvt_pk_bf16_f32 v148, v124, v125
  v_cvt_pk_bf16_f32 v149, v126, v127
  v_mfma_f32_32x32x16_bf16 v[76:91], v[168:171], v[144:147], v[76:91]
  buffer_load_dwordx4 v[216:219], v2, s[24:27], s45 offen offset:3072 sc1
  v_exp_f32 v132, v132
  v_exp_f32 v133, v133
  v_exp_f32 v134, v134
  v_exp_f32 v135, v135
  v_cvt_pk_bf16_f32 v150, v128, v129
  v_cvt_pk_bf16_f32 v151, v130, v131
  v_exp_f32 v136, v136
  v_exp_f32 v137, v137
  v_mfma_f32_32x32x16_bf16 v[92:107], v[164:167], v[148:151], v[92:107]
  buffer_load_dwordx4 a[40:43], v2, s[24:27], s46 offen offset:2048 sc1
  buffer_load_dwordx4 a[44:47], v2, s[24:27], s46 offen offset:3072 sc1
  v_exp_f32 v138, v138
  v_exp_f32 v139, v139
  v_cvt_pk_bf16_f32 v152, v132, v133
  v_cvt_pk_bf16_f32 v153, v134, v135
  v_cvt_pk_bf16_f32 v154, v136, v137
  v_cvt_pk_bf16_f32 v155, v138, v139
  v_mfma_f32_32x32x16_bf16 v[124:139], v[172:175], v[20:23], 0
  v_exp_f32 v108, v108
  v_exp_f32 v109, v109
  v_exp_f32 v110, v110
  v_exp_f32 v111, v111
  v_mfma_f32_32x32x16_bf16 v[124:139], v[176:179], v[24:27], v[124:139]
  v_exp_f32 v112, v112
  v_exp_f32 v113, v113
  v_exp_f32 v114, v114
  v_exp_f32 v115, v115
  v_cvt_pk_bf16_f32 v140, v108, v109
  v_cvt_pk_bf16_f32 v141, v110, v111
  v_mfma_f32_32x32x16_bf16 v[92:107], v[168:171], v[152:155], v[92:107]
  s_add_u32 s45, s44, 49152
  buffer_load_dwordx4 v[156:159], v2, s[24:27], s45 offen offset:0 sc1
  v_exp_f32 v116, v116
  v_exp_f32 v117, v117
  v_exp_f32 v118, v118
  v_exp_f32 v119, v119
  v_cvt_pk_bf16_f32 v142, v112, v113
  v_cvt_pk_bf16_f32 v143, v114, v115
  v_exp_f32 v120, v120
  v_exp_f32 v121, v121
  v_mfma_f32_32x32x16_bf16 v[44:59], v[180:183], v[140:143], v[44:59]
  s_add_u32 s46, s53, 12288
  buffer_load_dwordx4 a[48:51], v2, s[24:27], s46 offen offset:0 sc1
  v_exp_f32 v122, v122
  v_exp_f32 v123, v123
  v_cvt_pk_bf16_f32 v144, v116, v117
  v_cvt_pk_bf16_f32 v145, v118, v119
  v_cvt_pk_bf16_f32 v146, v120, v121
  v_cvt_pk_bf16_f32 v147, v122, v123
  v_mfma_f32_32x32x16_bf16 v[108:123], v[172:175], v[28:31], 0
  v_exp_f32 v124, v124
  v_exp_f32 v125, v125
  v_exp_f32 v126, v126
  v_exp_f32 v127, v127
  v_mfma_f32_32x32x16_bf16 v[108:123], v[176:179], v[32:35], v[108:123]
  v_exp_f32 v128, v128
  v_exp_f32 v129, v129
  v_exp_f32 v130, v130
  v_exp_f32 v131, v131
  v_cvt_pk_bf16_f32 v148, v124, v125
  v_cvt_pk_bf16_f32 v149, v126, v127
  v_mfma_f32_32x32x16_bf16 v[44:59], v[184:187], v[144:147], v[44:59]
  buffer_load_dwordx4 v[160:163], v2, s[24:27], s45 offen offset:1024 sc1
  v_exp_f32 v132, v132
  v_exp_f32 v133, v133
  v_exp_f32 v134, v134
  v_exp_f32 v135, v135
  v_cvt_pk_bf16_f32 v150, v128, v129
  v_cvt_pk_bf16_f32 v151, v130, v131
  v_exp_f32 v136, v136
  v_exp_f32 v137, v137
  v_mfma_f32_32x32x16_bf16 v[60:75], v[180:183], v[148:151], v[60:75]
  buffer_load_dwordx4 a[52:55], v2, s[24:27], s46 offen offset:1024 sc1
  v_exp_f32 v138, v138
  v_exp_f32 v139, v139
  v_cvt_pk_bf16_f32 v152, v132, v133
  v_cvt_pk_bf16_f32 v153, v134, v135
  v_cvt_pk_bf16_f32 v154, v136, v137
  v_cvt_pk_bf16_f32 v155, v138, v139
  v_mfma_f32_32x32x16_bf16 v[124:139], v[172:175], v[36:39], 0
  v_exp_f32 v108, v108
  v_exp_f32 v109, v109
  v_exp_f32 v110, v110
  v_exp_f32 v111, v111
  v_mfma_f32_32x32x16_bf16 v[124:139], v[176:179], v[40:43], v[124:139]
  v_exp_f32 v112, v112
  v_exp_f32 v113, v113
  v_exp_f32 v114, v114
  v_exp_f32 v115, v115
  v_cvt_pk_bf16_f32 v140, v108, v109
  v_cvt_pk_bf16_f32 v141, v110, v111
  v_mfma_f32_32x32x16_bf16 v[60:75], v[184:187], v[152:155], v[60:75]
  buffer_load_dwordx4 v[164:167], v2, s[24:27], s45 offen offset:2048 sc1
  v_exp_f32 v116, v116
  v_exp_f32 v117, v117
  v_exp_f32 v118, v118
  v_exp_f32 v119, v119
  v_cvt_pk_bf16_f32 v142, v112, v113
  v_cvt_pk_bf16_f32 v143, v114, v115
  v_exp_f32 v120, v120
  v_exp_f32 v121, v121
  v_mfma_f32_32x32x16_bf16 v[76:91], v[180:183], v[140:143], v[76:91]
  buffer_load_dwordx4 a[56:59], v2, s[24:27], s46 offen offset:2048 sc1
  buffer_load_dwordx4 a[60:63], v2, s[24:27], s46 offen offset:3072 sc1
  v_exp_f32 v122, v122
  v_exp_f32 v123, v123
  v_cvt_pk_bf16_f32 v144, v116, v117
  v_cvt_pk_bf16_f32 v145, v118, v119
  v_cvt_pk_bf16_f32 v146, v120, v121
  v_cvt_pk_bf16_f32 v147, v122, v123
  s_waitcnt vmcnt(18)
  v_mfma_f32_32x32x16_bf16 v[108:123], v[188:191], v[12:15], 0
  v_exp_f32 v124, v124
  v_exp_f32 v125, v125
  v_exp_f32 v126, v126
  v_exp_f32 v127, v127
  v_mfma_f32_32x32x16_bf16 v[108:123], v[192:195], v[16:19], v[108:123]
  v_exp_f32 v128, v128
  v_exp_f32 v129, v129
  v_exp_f32 v130, v130
  v_exp_f32 v131, v131
  v_cvt_pk_bf16_f32 v148, v124, v125
  v_cvt_pk_bf16_f32 v149, v126, v127
  v_mfma_f32_32x32x16_bf16 v[76:91], v[184:187], v[144:147], v[76:91]
  buffer_load_dwordx4 v[168:171], v2, s[24:27], s45 offen offset:3072 sc1
  v_exp_f32 v132, v132
  v_exp_f32 v133, v133
  v_exp_f32 v134, v134
  v_exp_f32 v135, v135
  v_cvt_pk_bf16_f32 v150, v128, v129
  v_cvt_pk_bf16_f32 v151, v130, v131
  v_exp_f32 v136, v136
  v_exp_f32 v137, v137
  v_mfma_f32_32x32x16_bf16 v[92:107], v[180:183], v[148:151], v[92:107]
  s_add_u32 s46, s53, 16384
  buffer_load_dwordx4 a[64:67], v2, s[24:27], s46 offen offset:0 sc1
  v_exp_f32 v138, v138
  v_exp_f32 v139, v139
  v_cvt_pk_bf16_f32 v152, v132, v133
  v_cvt_pk_bf16_f32 v153, v134, v135
  v_cvt_pk_bf16_f32 v154, v136, v137
  v_cvt_pk_bf16_f32 v155, v138, v139
  v_mfma_f32_32x32x16_bf16 v[124:139], v[188:191], v[20:23], 0
  v_exp_f32 v108, v108
  v_exp_f32 v109, v109
  v_exp_f32 v110, v110
  v_exp_f32 v111, v111
  v_mfma_f32_32x32x16_bf16 v[124:139], v[192:195], v[24:27], v[124:139]
  v_exp_f32 v112, v112
  v_exp_f32 v113, v113
  v_exp_f32 v114, v114
  v_exp_f32 v115, v115
  v_cvt_pk_bf16_f32 v140, v108, v109
  v_cvt_pk_bf16_f32 v141, v110, v111
  v_mfma_f32_32x32x16_bf16 v[92:107], v[184:187], v[152:155], v[92:107]
  s_add_u32 s45, s44, 53248
  buffer_load_dwordx4 v[172:175], v2, s[24:27], s45 offen offset:0 sc1
  v_exp_f32 v116, v116
  v_exp_f32 v117, v117
  v_exp_f32 v118, v118
  v_exp_f32 v119, v119
  v_cvt_pk_bf16_f32 v142, v112, v113
  v_cvt_pk_bf16_f32 v143, v114, v115
  v_exp_f32 v120, v120
  v_exp_f32 v121, v121
  v_mfma_f32_32x32x16_bf16 v[44:59], v[196:199], v[140:143], v[44:59]
  buffer_load_dwordx4 a[68:71], v2, s[24:27], s46 offen offset:1024 sc1
  v_exp_f32 v122, v122
  v_exp_f32 v123, v123
  v_cvt_pk_bf16_f32 v144, v116, v117
  v_cvt_pk_bf16_f32 v145, v118, v119
  v_cvt_pk_bf16_f32 v146, v120, v121
  v_cvt_pk_bf16_f32 v147, v122, v123
  v_mfma_f32_32x32x16_bf16 v[108:123], v[188:191], v[28:31], 0
  v_exp_f32 v124, v124
  v_exp_f32 v125, v125
  v_exp_f32 v126, v126
  v_exp_f32 v127, v127
  v_mfma_f32_32x32x16_bf16 v[108:123], v[192:195], v[32:35], v[108:123]
  v_exp_f32 v128, v128
  v_exp_f32 v129, v129
  v_exp_f32 v130, v130
  v_exp_f32 v131, v131
  v_cvt_pk_bf16_f32 v148, v124, v125
  v_cvt_pk_bf16_f32 v149, v126, v127
  v_mfma_f32_32x32x16_bf16 v[44:59], v[200:203], v[144:147], v[44:59]
  buffer_load_dwordx4 v[176:179], v2, s[24:27], s45 offen offset:1024 sc1
  v_exp_f32 v132, v132
  v_exp_f32 v133, v133
  v_exp_f32 v134, v134
  v_exp_f32 v135, v135
  v_cvt_pk_bf16_f32 v150, v128, v129
  v_cvt_pk_bf16_f32 v151, v130, v131
  v_exp_f32 v136, v136
  v_exp_f32 v137, v137
  v_mfma_f32_32x32x16_bf16 v[60:75], v[196:199], v[148:151], v[60:75]
  buffer_load_dwordx4 a[72:75], v2, s[24:27], s46 offen offset:2048 sc1
  v_exp_f32 v138, v138
  v_exp_f32 v139, v139
  v_cvt_pk_bf16_f32 v152, v132, v133
  v_cvt_pk_bf16_f32 v153, v134, v135
  v_cvt_pk_bf16_f32 v154, v136, v137
  v_cvt_pk_bf16_f32 v155, v138, v139
  v_mfma_f32_32x32x16_bf16 v[124:139], v[188:191], v[36:39], 0
  v_exp_f32 v108, v108
  v_exp_f32 v109, v109
  v_exp_f32 v110, v110
  v_exp_f32 v111, v111
  v_mfma_f32_32x32x16_bf16 v[124:139], v[192:195], v[40:43], v[124:139]
  v_exp_f32 v112, v112
  v_exp_f32 v113, v113
  v_exp_f32 v114, v114
  v_exp_f32 v115, v115
  v_cvt_pk_bf16_f32 v140, v108, v109
  v_cvt_pk_bf16_f32 v141, v110, v111
  v_mfma_f32_32x32x16_bf16 v[60:75], v[200:203], v[152:155], v[60:75]
  buffer_load_dwordx4 v[180:183], v2, s[24:27], s45 offen offset:2048 sc1
  v_exp_f32 v116, v116
  v_exp_f32 v117, v117
  v_exp_f32 v118, v118
  v_exp_f32 v119, v119
  v_cvt_pk_bf16_f32 v142, v112, v113
  v_cvt_pk_bf16_f32 v143, v114, v115
  v_exp_f32 v120, v120
  v_exp_f32 v121, v121
  v_mfma_f32_32x32x16_bf16 v[76:91], v[196:199], v[140:143], v[76:91]
  buffer_load_dwordx4 a[76:79], v2, s[24:27], s46 offen offset:3072 sc1
  s_add_u32 s46, s53, 20480
  buffer_load_dwordx4 a[80:83], v2, s[24:27], s46 offen offset:0 sc1
  v_exp_f32 v122, v122
  v_exp_f32 v123, v123
  v_cvt_pk_bf16_f32 v144, v116, v117
  v_cvt_pk_bf16_f32 v145, v118, v119
  v_cvt_pk_bf16_f32 v146, v120, v121
  v_cvt_pk_bf16_f32 v147, v122, v123
  s_waitcnt vmcnt(18)
  v_mfma_f32_32x32x16_bf16 v[108:123], v[204:207], v[12:15], 0
  v_exp_f32 v124, v124
  v_exp_f32 v125, v125
  v_exp_f32 v126, v126
  v_exp_f32 v127, v127
  v_mfma_f32_32x32x16_bf16 v[108:123], v[208:211], v[16:19], v[108:123]
  v_exp_f32 v128, v128
  v_exp_f32 v129, v129
  v_exp_f32 v130, v130
  v_exp_f32 v131, v131
  v_cvt_pk_bf16_f32 v148, v124, v125
  v_cvt_pk_bf16_f32 v149, v126, v127
  v_mfma_f32_32x32x16_bf16 v[76:91], v[200:203], v[144:147], v[76:91]
  buffer_load_dwordx4 v[184:187], v2, s[24:27], s45 offen offset:3072 sc1
  v_exp_f32 v132, v132
  v_exp_f32 v133, v133
  v_exp_f32 v134, v134
  v_exp_f32 v135, v135
  v_cvt_pk_bf16_f32 v150, v128, v129
  v_cvt_pk_bf16_f32 v151, v130, v131
  v_exp_f32 v136, v136
  v_exp_f32 v137, v137
  v_mfma_f32_32x32x16_bf16 v[92:107], v[196:199], v[148:151], v[92:107]
  buffer_load_dwordx4 a[84:87], v2, s[24:27], s46 offen offset:1024 sc1
  v_exp_f32 v138, v138
  v_exp_f32 v139, v139
  v_cvt_pk_bf16_f32 v152, v132, v133
  v_cvt_pk_bf16_f32 v153, v134, v135
  v_cvt_pk_bf16_f32 v154, v136, v137
  v_cvt_pk_bf16_f32 v155, v138, v139
  v_mfma_f32_32x32x16_bf16 v[124:139], v[204:207], v[20:23], 0
  v_exp_f32 v108, v108
  v_exp_f32 v109, v109
  v_exp_f32 v110, v110
  v_exp_f32 v111, v111
  v_mfma_f32_32x32x16_bf16 v[124:139], v[208:211], v[24:27], v[124:139]
  v_exp_f32 v112, v112
  v_exp_f32 v113, v113
  v_exp_f32 v114, v114
  v_exp_f32 v115, v115
  v_cvt_pk_bf16_f32 v140, v108, v109
  v_cvt_pk_bf16_f32 v141, v110, v111
  v_mfma_f32_32x32x16_bf16 v[92:107], v[200:203], v[152:155], v[92:107]
  s_add_u32 s45, s44, 57344
  buffer_load_dwordx4 v[188:191], v2, s[24:27], s45 offen offset:0 sc1
  v_exp_f32 v116, v116
  v_exp_f32 v117, v117
  v_exp_f32 v118, v118
  v_exp_f32 v119, v119
  v_cvt_pk_bf16_f32 v142, v112, v113
  v_cvt_pk_bf16_f32 v143, v114, v115
  v_exp_f32 v120, v120
  v_exp_f32 v121, v121
  v_mfma_f32_32x32x16_bf16 v[44:59], v[212:215], v[140:143], v[44:59]
  buffer_load_dwordx4 a[88:91], v2, s[24:27], s46 offen offset:2048 sc1
  v_exp_f32 v122, v122
  v_exp_f32 v123, v123
  v_cvt_pk_bf16_f32 v144, v116, v117
  v_cvt_pk_bf16_f32 v145, v118, v119
  v_cvt_pk_bf16_f32 v146, v120, v121
  v_cvt_pk_bf16_f32 v147, v122, v123
  v_mfma_f32_32x32x16_bf16 v[108:123], v[204:207], v[28:31], 0
  v_exp_f32 v124, v124
  v_exp_f32 v125, v125
  v_exp_f32 v126, v126
  v_exp_f32 v127, v127
  v_mfma_f32_32x32x16_bf16 v[108:123], v[208:211], v[32:35], v[108:123]
  v_exp_f32 v128, v128
  v_exp_f32 v129, v129
  v_exp_f32 v130, v130
  v_exp_f32 v131, v131
  v_cvt_pk_bf16_f32 v148, v124, v125
  v_cvt_pk_bf16_f32 v149, v126, v127
  v_mfma_f32_32x32x16_bf16 v[44:59], v[216:219], v[144:147], v[44:59]
  buffer_load_dwordx4 v[192:195], v2, s[24:27], s45 offen offset:1024 sc1
  v_exp_f32 v132, v132
  v_exp_f32 v133, v133
  v_exp_f32 v134, v134
  v_exp_f32 v135, v135
  v_cvt_pk_bf16_f32 v150, v128, v129
  v_cvt_pk_bf16_f32 v151, v130, v131
  v_exp_f32 v136, v136
  v_exp_f32 v137, v137
  v_mfma_f32_32x32x16_bf16 v[60:75], v[212:215], v[148:151], v[60:75]
  buffer_load_dwordx4 a[92:95], v2, s[24:27], s46 offen offset:3072 sc1
  v_exp_f32 v138, v138
  v_exp_f32 v139, v139
  v_cvt_pk_bf16_f32 v152, v132, v133
  v_cvt_pk_bf16_f32 v153, v134, v135
  v_cvt_pk_bf16_f32 v154, v136, v137
  v_cvt_pk_bf16_f32 v155, v138, v139
  v_mfma_f32_32x32x16_bf16 v[124:139], v[204:207], v[36:39], 0
  v_exp_f32 v108, v108
  v_exp_f32 v109, v109
  v_exp_f32 v110, v110
  v_exp_f32 v111, v111
  v_mfma_f32_32x32x16_bf16 v[124:139], v[208:211], v[40:43], v[124:139]
  v_exp_f32 v112, v112
  v_exp_f32 v113, v113
  v_exp_f32 v114, v114
  v_exp_f32 v115, v115
  v_cvt_pk_bf16_f32 v140, v108, v109
  v_cvt_pk_bf16_f32 v141, v110, v111
  v_mfma_f32_32x32x16_bf16 v[60:75], v[216:219], v[152:155], v[60:75]
  buffer_load_dwordx4 v[196:199], v2, s[24:27], s45 offen offset:2048 sc1
  v_exp_f32 v116, v116
  v_exp_f32 v117, v117
  v_exp_f32 v118, v118
  v_exp_f32 v119, v119
  v_cvt_pk_bf16_f32 v142, v112, v113
  v_cvt_pk_bf16_f32 v143, v114, v115
  v_exp_f32 v120, v120
  v_exp_f32 v121, v121
  v_mfma_f32_32x32x16_bf16 v[76:91], v[212:215], v[140:143], v[76:91]
  s_add_u32 s46, s53, 24576
  buffer_load_dwordx4 a[96:99], v2, s[24:27], s46 offen offset:0 sc1
  buffer_load_dwordx4 a[100:103], v2, s[24:27], s46 offen offset:1024 sc1
  v_exp_f32 v122, v122
  v_exp_f32 v123, v123
  v_cvt_pk_bf16_f32 v144, v116, v117
  v_cvt_pk_bf16_f32 v145, v118, v119
  v_cvt_pk_bf16_f32 v146, v120, v121
  v_cvt_pk_bf16_f32 v147, v122, v123
  s_waitcnt vmcnt(17)
  v_mfma_f32_32x32x16_bf16 v[108:123], v[156:159], v[12:15], 0
  v_exp_f32 v124, v124
  v_exp_f32 v125, v125
  v_exp_f32 v126, v126
  v_exp_f32 v127, v127
  v_mfma_f32_32x32x16_bf16 v[108:123], v[160:163], v[16:19], v[108:123]
  v_exp_f32 v128, v128
  v_exp_f32 v129, v129
  v_exp_f32 v130, v130
  v_exp_f32 v131, v131
  v_cvt_pk_bf16_f32 v148, v124, v125
  v_cvt_pk_bf16_f32 v149, v126, v127
  v_mfma_f32_32x32x16_bf16 v[76:91], v[216:219], v[144:147], v[76:91]
  buffer_load_dwordx4 v[200:203], v2, s[24:27], s45 offen offset:3072 sc1
  v_exp_f32 v132, v132
  v_exp_f32 v133, v133
  v_exp_f32 v134, v134
  v_exp_f32 v135, v135
  v_cvt_pk_bf16_f32 v150, v128, v129
  v_cvt_pk_bf16_f32 v151, v130, v131
  v_exp_f32 v136, v136
  v_exp_f32 v137, v137
  v_mfma_f32_32x32x16_bf16 v[92:107], v[212:215], v[148:151], v[92:107]
  buffer_load_dwordx4 a[104:107], v2, s[24:27], s46 offen offset:2048 sc1
  v_exp_f32 v138, v138
  v_exp_f32 v139, v139
  v_cvt_pk_bf16_f32 v152, v132, v133
  v_cvt_pk_bf16_f32 v153, v134, v135
  v_cvt_pk_bf16_f32 v154, v136, v137
  v_cvt_pk_bf16_f32 v155, v138, v139
  v_mfma_f32_32x32x16_bf16 v[124:139], v[156:159], v[20:23], 0
  v_exp_f32 v108, v108
  v_exp_f32 v109, v109
  v_exp_f32 v110, v110
  v_exp_f32 v111, v111
  v_mfma_f32_32x32x16_bf16 v[124:139], v[160:163], v[24:27], v[124:139]
  v_exp_f32 v112, v112
  v_exp_f32 v113, v113
  v_exp_f32 v114, v114
  v_exp_f32 v115, v115
  v_cvt_pk_bf16_f32 v140, v108, v109
  v_cvt_pk_bf16_f32 v141, v110, v111
  v_mfma_f32_32x32x16_bf16 v[92:107], v[216:219], v[152:155], v[92:107]
  s_add_u32 s45, s44, 61440
  buffer_load_dwordx4 v[204:207], v2, s[24:27], s45 offen offset:0 sc1
  v_exp_f32 v116, v116
  v_exp_f32 v117, v117
  v_exp_f32 v118, v118
  v_exp_f32 v119, v119
  v_cvt_pk_bf16_f32 v142, v112, v113
  v_cvt_pk_bf16_f32 v143, v114, v115
  v_exp_f32 v120, v120
  v_exp_f32 v121, v121
  v_mfma_f32_32x32x16_bf16 v[44:59], v[164:167], v[140:143], v[44:59]
  buffer_load_dwordx4 a[108:111], v2, s[24:27], s46 offen offset:3072 sc1
  v_exp_f32 v122, v122
  v_exp_f32 v123, v123
  v_cvt_pk_bf16_f32 v144, v116, v117
  v_cvt_pk_bf16_f32 v145, v118, v119
  v_cvt_pk_bf16_f32 v146, v120, v121
  v_cvt_pk_bf16_f32 v147, v122, v123
  v_mfma_f32_32x32x16_bf16 v[108:123], v[156:159], v[28:31], 0
  v_exp_f32 v124, v124
  v_exp_f32 v125, v125
  v_exp_f32 v126, v126
  v_exp_f32 v127, v127
  v_mfma_f32_32x32x16_bf16 v[108:123], v[160:163], v[32:35], v[108:123]
  v_exp_f32 v128, v128
  v_exp_f32 v129, v129
  v_exp_f32 v130, v130
  v_exp_f32 v131, v131
  v_cvt_pk_bf16_f32 v148, v124, v125
  v_cvt_pk_bf16_f32 v149, v126, v127
  v_mfma_f32_32x32x16_bf16 v[44:59], v[168:171], v[144:147], v[44:59]
  buffer_load_dwordx4 v[208:211], v2, s[24:27], s45 offen offset:1024 sc1
  v_exp_f32 v132, v132
  v_exp_f32 v133, v133
  v_exp_f32 v134, v134
  v_exp_f32 v135, v135
  v_cvt_pk_bf16_f32 v150, v128, v129
  v_cvt_pk_bf16_f32 v151, v130, v131
  v_exp_f32 v136, v136
  v_exp_f32 v137, v137
  v_mfma_f32_32x32x16_bf16 v[60:75], v[164:167], v[148:151], v[60:75]
  s_add_u32 s46, s53, 28672
  buffer_load_dwordx4 a[112:115], v2, s[24:27], s46 offen offset:0 sc1
  buffer_load_dwordx4 a[116:119], v2, s[24:27], s46 offen offset:1024 sc1
  v_exp_f32 v138, v138
  v_exp_f32 v139, v139
  v_cvt_pk_bf16_f32 v152, v132, v133
  v_cvt_pk_bf16_f32 v153, v134, v135
  v_cvt_pk_bf16_f32 v154, v136, v137
  v_cvt_pk_bf16_f32 v155, v138, v139
  v_mfma_f32_32x32x16_bf16 v[124:139], v[156:159], v[36:39], 0
  v_exp_f32 v108, v108
  v_exp_f32 v109, v109
  v_exp_f32 v110, v110
  v_exp_f32 v111, v111
  v_mfma_f32_32x32x16_bf16 v[124:139], v[160:163], v[40:43], v[124:139]
  v_exp_f32 v112, v112
  v_exp_f32 v113, v113
  v_exp_f32 v114, v114
  v_exp_f32 v115, v115
  v_cvt_pk_bf16_f32 v140, v108, v109
  v_cvt_pk_bf16_f32 v141, v110, v111
  v_mfma_f32_32x32x16_bf16 v[60:75], v[168:171], v[152:155], v[60:75]
  buffer_load_dwordx4 v[212:215], v2, s[24:27], s45 offen offset:2048 sc1
  v_exp_f32 v116, v116
  v_exp_f32 v117, v117
  v_exp_f32 v118, v118
  v_exp_f32 v119, v119
  v_cvt_pk_bf16_f32 v142, v112, v113
  v_cvt_pk_bf16_f32 v143, v114, v115
  v_exp_f32 v120, v120
  v_exp_f32 v121, v121
  v_mfma_f32_32x32x16_bf16 v[76:91], v[164:167], v[140:143], v[76:91]
  buffer_load_dwordx4 a[120:123], v2, s[24:27], s46 offen offset:2048 sc1
  v_exp_f32 v122, v122
  v_exp_f32 v123, v123
  v_cvt_pk_bf16_f32 v144, v116, v117
  v_cvt_pk_bf16_f32 v145, v118, v119
  v_cvt_pk_bf16_f32 v146, v120, v121
  v_cvt_pk_bf16_f32 v147, v122, v123
  s_waitcnt vmcnt(17)
  v_mfma_f32_32x32x16_bf16 v[108:123], v[172:175], v[12:15], 0
  v_exp_f32 v124, v124
  v_exp_f32 v125, v125
  v_exp_f32 v126, v126
  v_exp_f32 v127, v127
  v_mfma_f32_32x32x16_bf16 v[108:123], v[176:179], v[16:19], v[108:123]
  v_exp_f32 v128, v128
  v_exp_f32 v129, v129
  v_exp_f32 v130, v130
  v_exp_f32 v131, v131
  v_cvt_pk_bf16_f32 v148, v124, v125
  v_cvt_pk_bf16_f32 v149, v126, v127
  v_mfma_f32_32x32x16_bf16 v[76:91], v[168:171], v[144:147], v[76:91]
  buffer_load_dwordx4 v[216:219], v2, s[24:27], s45 offen offset:3072 sc1
  v_exp_f32 v132, v132
  v_exp_f32 v133, v133
  v_exp_f32 v134, v134
  v_exp_f32 v135, v135
  v_cvt_pk_bf16_f32 v150, v128, v129
  v_cvt_pk_bf16_f32 v151, v130, v131
  v_exp_f32 v136, v136
  v_exp_f32 v137, v137
  v_mfma_f32_32x32x16_bf16 v[92:107], v[164:167], v[148:151], v[92:107]
  buffer_load_dwordx4 a[124:127], v2, s[24:27], s46 offen offset:3072 sc1
  v_exp_f32 v138, v138
  v_exp_f32 v139, v139
  v_cvt_pk_bf16_f32 v152, v132, v133
  v_cvt_pk_bf16_f32 v153, v134, v135
  v_cvt_pk_bf16_f32 v154, v136, v137
  v_cvt_pk_bf16_f32 v155, v138, v139
  v_mfma_f32_32x32x16_bf16 v[124:139], v[172:175], v[20:23], 0
  v_exp_f32 v108, v108
  v_exp_f32 v109, v109
  v_exp_f32 v110, v110
  v_exp_f32 v111, v111
  v_mfma_f32_32x32x16_bf16 v[124:139], v[176:179], v[24:27], v[124:139]
  v_exp_f32 v112, v112
  v_exp_f32 v113, v113
  v_exp_f32 v114, v114
  v_exp_f32 v115, v115
  v_cvt_pk_bf16_f32 v140, v108, v109
  v_cvt_pk_bf16_f32 v141, v110, v111
  v_mfma_f32_32x32x16_bf16 v[92:107], v[168:171], v[152:155], v[92:107]
  v_exp_f32 v116, v116
  v_exp_f32 v117, v117
  v_exp_f32 v118, v118
  v_exp_f32 v119, v119
  v_cvt_pk_bf16_f32 v142, v112, v113
  v_cvt_pk_bf16_f32 v143, v114, v115
  v_exp_f32 v120, v120
  v_exp_f32 v121, v121
  v_mfma_f32_32x32x16_bf16 v[44:59], v[180:183], v[140:143], v[44:59]
  s_add_u32 s46, s53, 32768
  buffer_load_dwordx4 a[128:131], v2, s[24:27], s46 offen offset:0 sc1
  v_exp_f32 v122, v122
  v_exp_f32 v123, v123
  v_cvt_pk_bf16_f32 v144, v116, v117
  v_cvt_pk_bf16_f32 v145, v118, v119
  v_cvt_pk_bf16_f32 v146, v120, v121
  v_cvt_pk_bf16_f32 v147, v122, v123
  v_mfma_f32_32x32x16_bf16 v[108:123], v[172:175], v[28:31], 0
  v_exp_f32 v124, v124
  v_exp_f32 v125, v125
  v_exp_f32 v126, v126
  v_exp_f32 v127, v127
  v_mfma_f32_32x32x16_bf16 v[108:123], v[176:179], v[32:35], v[108:123]
  v_exp_f32 v128, v128
  v_exp_f32 v129, v129
  v_exp_f32 v130, v130
  v_exp_f32 v131, v131
  v_cvt_pk_bf16_f32 v148, v124, v125
  v_cvt_pk_bf16_f32 v149, v126, v127
  v_mfma_f32_32x32x16_bf16 v[44:59], v[184:187], v[144:147], v[44:59]
  v_exp_f32 v132, v132
  v_exp_f32 v133, v133
  v_exp_f32 v134, v134
  v_exp_f32 v135, v135
  v_cvt_pk_bf16_f32 v150, v128, v129
  v_cvt_pk_bf16_f32 v151, v130, v131
  v_exp_f32 v136, v136
  v_exp_f32 v137, v137
  v_mfma_f32_32x32x16_bf16 v[60:75], v[180:183], v[148:151], v[60:75]
  buffer_load_dwordx4 a[132:135], v2, s[24:27], s46 offen offset:1024 sc1
  buffer_load_dwordx4 a[136:139], v2, s[24:27], s46 offen offset:2048 sc1
  v_exp_f32 v138, v138
  v_exp_f32 v139, v139
  v_cvt_pk_bf16_f32 v152, v132, v133
  v_cvt_pk_bf16_f32 v153, v134, v135
  v_cvt_pk_bf16_f32 v154, v136, v137
  v_cvt_pk_bf16_f32 v155, v138, v139
  v_mfma_f32_32x32x16_bf16 v[124:139], v[172:175], v[36:39], 0
  v_exp_f32 v108, v108
  v_exp_f32 v109, v109
  v_exp_f32 v110, v110
  v_exp_f32 v111, v111
  v_mfma_f32_32x32x16_bf16 v[124:139], v[176:179], v[40:43], v[124:139]
  v_exp_f32 v112, v112
  v_exp_f32 v113, v113
  v_exp_f32 v114, v114
  v_exp_f32 v115, v115
  v_cvt_pk_bf16_f32 v140, v108, v109
  v_cvt_pk_bf16_f32 v141, v110, v111
  v_mfma_f32_32x32x16_bf16 v[60:75], v[184:187], v[152:155], v[60:75]
  v_exp_f32 v116, v116
  v_exp_f32 v117, v117
  v_exp_f32 v118, v118
  v_exp_f32 v119, v119
  v_cvt_pk_bf16_f32 v142, v112, v113
  v_cvt_pk_bf16_f32 v143, v114, v115
  v_exp_f32 v120, v120
  v_exp_f32 v121, v121
  v_mfma_f32_32x32x16_bf16 v[76:91], v[180:183], v[140:143], v[76:91]
  buffer_load_dwordx4 a[140:143], v2, s[24:27], s46 offen offset:3072 sc1
  v_exp_f32 v122, v122
  v_exp_f32 v123, v123
  v_cvt_pk_bf16_f32 v144, v116, v117
  v_cvt_pk_bf16_f32 v145, v118, v119
  v_cvt_pk_bf16_f32 v146, v120, v121
  v_cvt_pk_bf16_f32 v147, v122, v123
  s_waitcnt vmcnt(14)
  v_mfma_f32_32x32x16_bf16 v[108:123], v[188:191], v[12:15], 0
  v_exp_f32 v124, v124
  v_exp_f32 v125, v125
  v_exp_f32 v126, v126
  v_exp_f32 v127, v127
  v_mfma_f32_32x32x16_bf16 v[108:123], v[192:195], v[16:19], v[108:123]
  v_exp_f32 v128, v128
  v_exp_f32 v129, v129
  v_exp_f32 v130, v130
  v_exp_f32 v131, v131
  v_cvt_pk_bf16_f32 v148, v124, v125
  v_cvt_pk_bf16_f32 v149, v126, v127
  v_mfma_f32_32x32x16_bf16 v[76:91], v[184:187], v[144:147], v[76:91]
  v_exp_f32 v132, v132
  v_exp_f32 v133, v133
  v_exp_f32 v134, v134
  v_exp_f32 v135, v135
  v_cvt_pk_bf16_f32 v150, v128, v129
  v_cvt_pk_bf16_f32 v151, v130, v131
  v_exp_f32 v136, v136
  v_exp_f32 v137, v137
  v_mfma_f32_32x32x16_bf16 v[92:107], v[180:183], v[148:151], v[92:107]
  s_add_u32 s46, s53, 36864
  buffer_load_dwordx4 a[144:147], v2, s[24:27], s46 offen offset:0 sc1
  v_exp_f32 v138, v138
  v_exp_f32 v139, v139
  v_cvt_pk_bf16_f32 v152, v132, v133
  v_cvt_pk_bf16_f32 v153, v134, v135
  v_cvt_pk_bf16_f32 v154, v136, v137
  v_cvt_pk_bf16_f32 v155, v138, v139
  v_mfma_f32_32x32x16_bf16 v[124:139], v[188:191], v[20:23], 0
  v_exp_f32 v108, v108
  v_exp_f32 v109, v109
  v_exp_f32 v110, v110
  v_exp_f32 v111, v111
  v_mfma_f32_32x32x16_bf16 v[124:139], v[192:195], v[24:27], v[124:139]
  v_exp_f32 v112, v112
  v_exp_f32 v113, v113
  v_exp_f32 v114, v114
  v_exp_f32 v115, v115
  v_cvt_pk_bf16_f32 v140, v108, v109
  v_cvt_pk_bf16_f32 v141, v110, v111
  v_mfma_f32_32x32x16_bf16 v[92:107], v[184:187], v[152:155], v[92:107]
  v_exp_f32 v116, v116
  v_exp_f32 v117, v117
  v_exp_f32 v118, v118
  v_exp_f32 v119, v119
  v_cvt_pk_bf16_f32 v142, v112, v113
  v_cvt_pk_bf16_f32 v143, v114, v115
  v_exp_f32 v120, v120
  v_exp_f32 v121, v121
  v_mfma_f32_32x32x16_bf16 v[44:59], v[196:199], v[140:143], v[44:59]
  buffer_load_dwordx4 a[148:151], v2, s[24:27], s46 offen offset:1024 sc1
  buffer_load_dwordx4 a[152:155], v2, s[24:27], s46 offen offset:2048 sc1
  v_exp_f32 v122, v122
  v_exp_f32 v123, v123
  v_cvt_pk_bf16_f32 v144, v116, v117
  v_cvt_pk_bf16_f32 v145, v118, v119
  v_cvt_pk_bf16_f32 v146, v120, v121
  v_cvt_pk_bf16_f32 v147, v122, v123
  v_mfma_f32_32x32x16_bf16 v[108:123], v[188:191], v[28:31], 0
  v_exp_f32 v124, v124
  v_exp_f32 v125, v125
  v_exp_f32 v126, v126
  v_exp_f32 v127, v127
  v_mfma_f32_32x32x16_bf16 v[108:123], v[192:195], v[32:35], v[108:123]
  v_exp_f32 v128, v128
  v_exp_f32 v129, v129
  v_exp_f32 v130, v130
  v_exp_f32 v131, v131
  v_cvt_pk_bf16_f32 v148, v124, v125
  v_cvt_pk_bf16_f32 v149, v126, v127
  v_mfma_f32_32x32x16_bf16 v[44:59], v[200:203], v[144:147], v[44:59]
  v_exp_f32 v132, v132
  v_exp_f32 v133, v133
  v_exp_f32 v134, v134
  v_exp_f32 v135, v135
  v_cvt_pk_bf16_f32 v150, v128, v129
  v_cvt_pk_bf16_f32 v151, v130, v131
  v_exp_f32 v136, v136
  v_exp_f32 v137, v137
  v_mfma_f32_32x32x16_bf16 v[60:75], v[196:199], v[148:151], v[60:75]
  buffer_load_dwordx4 a[156:159], v2, s[24:27], s46 offen offset:3072 sc1
  v_exp_f32 v138, v138
  v_exp_f32 v139, v139
  v_cvt_pk_bf16_f32 v152, v132, v133
  v_cvt_pk_bf16_f32 v153, v134, v135
  v_cvt_pk_bf16_f32 v154, v136, v137
  v_cvt_pk_bf16_f32 v155, v138, v139
  v_mfma_f32_32x32x16_bf16 v[124:139], v[188:191], v[36:39], 0
  v_exp_f32 v108, v108
  v_exp_f32 v109, v109
  v_exp_f32 v110, v110
  v_exp_f32 v111, v111
  v_mfma_f32_32x32x16_bf16 v[124:139], v[192:195], v[40:43], v[124:139]
  v_exp_f32 v112, v112
  v_exp_f32 v113, v113
  v_exp_f32 v114, v114
  v_exp_f32 v115, v115
  v_cvt_pk_bf16_f32 v140, v108, v109
  v_cvt_pk_bf16_f32 v141, v110, v111
  v_mfma_f32_32x32x16_bf16 v[60:75], v[200:203], v[152:155], v[60:75]
  v_exp_f32 v116, v116
  v_exp_f32 v117, v117
  v_exp_f32 v118, v118
  v_exp_f32 v119, v119
  v_cvt_pk_bf16_f32 v142, v112, v113
  v_cvt_pk_bf16_f32 v143, v114, v115
  v_exp_f32 v120, v120
  v_exp_f32 v121, v121
  v_mfma_f32_32x32x16_bf16 v[76:91], v[196:199], v[140:143], v[76:91]
  s_add_u32 s46, s53, 40960
  buffer_load_dwordx4 a[160:163], v2, s[24:27], s46 offen offset:0 sc1
  v_exp_f32 v122, v122
  v_exp_f32 v123, v123
  v_cvt_pk_bf16_f32 v144, v116, v117
  v_cvt_pk_bf16_f32 v145, v118, v119
  v_cvt_pk_bf16_f32 v146, v120, v121
  v_cvt_pk_bf16_f32 v147, v122, v123
  s_waitcnt vmcnt(10)
  v_mfma_f32_32x32x16_bf16 v[108:123], v[204:207], v[12:15], 0
  v_exp_f32 v124, v124
  v_exp_f32 v125, v125
  v_exp_f32 v126, v126
  v_exp_f32 v127, v127
  v_mfma_f32_32x32x16_bf16 v[108:123], v[208:211], v[16:19], v[108:123]
  v_exp_f32 v128, v128
  v_exp_f32 v129, v129
  v_exp_f32 v130, v130
  v_exp_f32 v131, v131
  v_cvt_pk_bf16_f32 v148, v124, v125
  v_cvt_pk_bf16_f32 v149, v126, v127
  v_mfma_f32_32x32x16_bf16 v[76:91], v[200:203], v[144:147], v[76:91]
  v_exp_f32 v132, v132
  v_exp_f32 v133, v133
  v_exp_f32 v134, v134
  v_exp_f32 v135, v135
  v_cvt_pk_bf16_f32 v150, v128, v129
  v_cvt_pk_bf16_f32 v151, v130, v131
  v_exp_f32 v136, v136
  v_exp_f32 v137, v137
  v_mfma_f32_32x32x16_bf16 v[92:107], v[196:199], v[148:151], v[92:107]
  buffer_load_dwordx4 a[164:167], v2, s[24:27], s46 offen offset:1024 sc1
  v_exp_f32 v138, v138
  v_exp_f32 v139, v139
  v_cvt_pk_bf16_f32 v152, v132, v133
  v_cvt_pk_bf16_f32 v153, v134, v135
  v_cvt_pk_bf16_f32 v154, v136, v137
  v_cvt_pk_bf16_f32 v155, v138, v139
  v_mfma_f32_32x32x16_bf16 v[124:139], v[204:207], v[20:23], 0
  v_exp_f32 v108, v108
  v_exp_f32 v109, v109
  v_exp_f32 v110, v110
  v_exp_f32 v111, v111
  v_mfma_f32_32x32x16_bf16 v[124:139], v[208:211], v[24:27], v[124:139]
  v_exp_f32 v112, v112
  v_exp_f32 v113, v113
  v_exp_f32 v114, v114
  v_exp_f32 v115, v115
  v_cvt_pk_bf16_f32 v140, v108, v109
  v_cvt_pk_bf16_f32 v141, v110, v111
  v_mfma_f32_32x32x16_bf16 v[92:107], v[200:203], v[152:155], v[92:107]
  v_exp_f32 v116, v116
  v_exp_f32 v117, v117
  v_exp_f32 v118, v118
  v_exp_f32 v119, v119
  v_cvt_pk_bf16_f32 v142, v112, v113
  v_cvt_pk_bf16_f32 v143, v114, v115
  v_exp_f32 v120, v120
  v_exp_f32 v121, v121
  v_mfma_f32_32x32x16_bf16 v[44:59], v[212:215], v[140:143], v[44:59]
  buffer_load_dwordx4 a[168:171], v2, s[24:27], s46 offen offset:2048 sc1
  buffer_load_dwordx4 a[172:175], v2, s[24:27], s46 offen offset:3072 sc1
  v_exp_f32 v122, v122
  v_exp_f32 v123, v123
  v_cvt_pk_bf16_f32 v144, v116, v117
  v_cvt_pk_bf16_f32 v145, v118, v119
  v_cvt_pk_bf16_f32 v146, v120, v121
  v_cvt_pk_bf16_f32 v147, v122, v123
  v_mfma_f32_32x32x16_bf16 v[108:123], v[204:207], v[28:31], 0
  v_exp_f32 v124, v124
  v_exp_f32 v125, v125
  v_exp_f32 v126, v126
  v_exp_f32 v127, v127
  v_mfma_f32_32x32x16_bf16 v[108:123], v[208:211], v[32:35], v[108:123]
  v_exp_f32 v128, v128
  v_exp_f32 v129, v129
  v_exp_f32 v130, v130
  v_exp_f32 v131, v131
  v_cvt_pk_bf16_f32 v148, v124, v125
  v_cvt_pk_bf16_f32 v149, v126, v127
  v_mfma_f32_32x32x16_bf16 v[44:59], v[216:219], v[144:147], v[44:59]
  v_exp_f32 v132, v132
  v_exp_f32 v133, v133
  v_exp_f32 v134, v134
  v_exp_f32 v135, v135
  v_cvt_pk_bf16_f32 v150, v128, v129
  v_cvt_pk_bf16_f32 v151, v130, v131
  v_exp_f32 v136, v136
  v_exp_f32 v137, v137
  v_mfma_f32_32x32x16_bf16 v[60:75], v[212:215], v[148:151], v[60:75]
  s_add_u32 s46, s53, 45056
  buffer_load_dwordx4 a[176:179], v2, s[24:27], s46 offen offset:0 sc1
  v_exp_f32 v138, v138
  v_exp_f32 v139, v139
  v_cvt_pk_bf16_f32 v152, v132, v133
  v_cvt_pk_bf16_f32 v153, v134, v135
  v_cvt_pk_bf16_f32 v154, v136, v137
  v_cvt_pk_bf16_f32 v155, v138, v139
  v_mfma_f32_32x32x16_bf16 v[124:139], v[204:207], v[36:39], 0
  v_exp_f32 v108, v108
  v_exp_f32 v109, v109
  v_exp_f32 v110, v110
  v_exp_f32 v111, v111
  v_mfma_f32_32x32x16_bf16 v[124:139], v[208:211], v[40:43], v[124:139]
  v_exp_f32 v112, v112
  v_exp_f32 v113, v113
  v_exp_f32 v114, v114
  v_exp_f32 v115, v115
  v_cvt_pk_bf16_f32 v140, v108, v109
  v_cvt_pk_bf16_f32 v141, v110, v111
  v_mfma_f32_32x32x16_bf16 v[60:75], v[216:219], v[152:155], v[60:75]
  v_exp_f32 v116, v116
  v_exp_f32 v117, v117
  v_exp_f32 v118, v118
  v_exp_f32 v119, v119
  v_cvt_pk_bf16_f32 v142, v112, v113
  v_cvt_pk_bf16_f32 v143, v114, v115
  v_exp_f32 v120, v120
  v_exp_f32 v121, v121
  v_mfma_f32_32x32x16_bf16 v[76:91], v[212:215], v[140:143], v[76:91]
  buffer_load_dwordx4 a[180:183], v2, s[24:27], s46 offen offset:1024 sc1
  v_exp_f32 v122, v122
  v_exp_f32 v123, v123
  v_cvt_pk_bf16_f32 v144, v116, v117
  v_cvt_pk_bf16_f32 v145, v118, v119
  v_cvt_pk_bf16_f32 v146, v120, v121
  v_cvt_pk_bf16_f32 v147, v122, v123
  v_exp_f32 v124, v124
  v_exp_f32 v125, v125
  v_exp_f32 v126, v126
  v_exp_f32 v127, v127
  v_exp_f32 v128, v128
  v_exp_f32 v129, v129
  v_exp_f32 v130, v130
  v_exp_f32 v131, v131
  v_cvt_pk_bf16_f32 v148, v124, v125
  v_cvt_pk_bf16_f32 v149, v126, v127
  v_mfma_f32_32x32x16_bf16 v[76:91], v[216:219], v[144:147], v[76:91]
  v_exp_f32 v132, v132
  v_exp_f32 v133, v133
  v_exp_f32 v134, v134
  v_exp_f32 v135, v135
  v_cvt_pk_bf16_f32 v150, v128, v129
  v_cvt_pk_bf16_f32 v151, v130, v131
  v_exp_f32 v136, v136
  v_exp_f32 v137, v137
  v_mfma_f32_32x32x16_bf16 v[92:107], v[212:215], v[148:151], v[92:107]
  buffer_load_dwordx4 a[184:187], v2, s[24:27], s46 offen offset:2048 sc1
  buffer_load_dwordx4 a[188:191], v2, s[24:27], s46 offen offset:3072 sc1
  v_exp_f32 v138, v138
  v_exp_f32 v139, v139
  v_cvt_pk_bf16_f32 v152, v132, v133
  v_cvt_pk_bf16_f32 v153, v134, v135
  v_cvt_pk_bf16_f32 v154, v136, v137
  v_cvt_pk_bf16_f32 v155, v138, v139
  s_nop 1
  v_mfma_f32_32x32x16_bf16 v[92:107], v[216:219], v[152:155], v[92:107]
  s_sub_u32 s50, s50, 4096
  s_sub_u32 s51, s51, 4096
  s_lshl_b32 s4, s10, 5
  s_lshl_b32 s5, s57, 1
  s_add_u32 s4, s4, s5
  s_lshl_b32 s4, s4, 10
  s_add_u32 s47, s4, s60
  s_nop 7
  ds_write_b128 v6, v[60:63] offset:0
  ds_write_b128 v6, v[64:67] offset:1024
  ds_write_b128 v6, v[68:71] offset:2048
  ds_write_b128 v6, v[72:75] offset:3072
  ds_write_b128 v7, v[76:79] offset:0
  ds_write_b128 v7, v[80:83] offset:1024
  ds_write_b128 v7, v[84:87] offset:2048
  ds_write_b128 v7, v[88:91] offset:3072
  ds_write_b128 v8, v[92:95] offset:0
  ds_write_b128 v8, v[96:99] offset:1024
  ds_write_b128 v8, v[100:103] offset:2048
  ds_write_b128 v8, v[104:107] offset:3072
  s_waitcnt lgkmcnt(0)
  s_barrier
  ds_read_b128 v[156:159], v5 offset:0
  ds_read_b128 v[160:163], v5 offset:1024
  ds_read_b128 v[164:167], v5 offset:2048
  ds_read_b128 v[168:171], v5 offset:3072
  ds_read_b128 v[172:175], v5 offset:4096
  ds_read_b128 v[176:179], v5 offset:5120
  ds_read_b128 v[180:183], v5 offset:6144
  ds_read_b128 v[184:187], v5 offset:7168
  ds_read_b128 v[188:191], v5 offset:8192
  ds_read_b128 v[192:195], v5 offset:9216
  ds_read_b128 v[196:199], v5 offset:10240
  ds_read_b128 v[200:203], v5 offset:11264
  s_waitcnt lgkmcnt(8)
  v_add_f32 v44, v44, v156
  v_add_f32 v45, v45, v157
  v_add_f32 v46, v46, v158
  v_add_f32 v47, v47, v159
  v_add_f32 v48, v48, v160
  v_add_f32 v49, v49, v161
  v_add_f32 v50, v50, v162
  v_add_f32 v51, v51, v163
  v_add_f32 v52, v52, v164
  v_add_f32 v53, v53, v165
  v_add_f32 v54, v54, v166
  v_add_f32 v55, v55, v167
  v_add_f32 v56, v56, v168
  v_add_f32 v57, v57, v169
  v_add_f32 v58, v58, v170
  v_add_f32 v59, v59, v171
  s_waitcnt lgkmcnt(4)
  v_add_f32 v44, v44, v172
  v_add_f32 v45, v45, v173
  v_add_f32 v46, v46, v174
  v_add_f32 v47, v47, v175
  v_add_f32 v48, v48, v176
  v_add_f32 v49, v49, v177
  v_add_f32 v50, v50, v178
  v_add_f32 v51, v51, v179
  v_add_f32 v52, v52, v180
  v_add_f32 v53, v53, v181
  v_add_f32 v54, v54, v182
  v_add_f32 v55, v55, v183
  v_add_f32 v56, v56, v184
  v_add_f32 v57, v57, v185
  v_add_f32 v58, v58, v186
  v_add_f32 v59, v59, v187
  s_waitcnt lgkmcnt(0)
  v_add_f32 v44, v44, v188
  v_add_f32 v45, v45, v189
  v_add_f32 v46, v46, v190
  v_add_f32 v47, v47, v191
  v_add_f32 v48, v48, v192
  v_add_f32 v49, v49, v193
  v_add_f32 v50, v50, v194
  v_add_f32 v51, v51, v195
  v_add_f32 v52, v52, v196
  v_add_f32 v53, v53, v197
  v_add_f32 v54, v54, v198
  v_add_f32 v55, v55, v199
  v_add_f32 v56, v56, v200
  v_add_f32 v57, v57, v201
  v_add_f32 v58, v58, v202
  v_add_f32 v59, v59, v203
  v_mov_b32 v220, v56
  v_mov_b32 v221, v56
  s_mov_b32 s5, 0x4e800000
  s_nop 0
  v_permlane32_swap_b32 v220, v221
  s_nop 1
  v_rcp_f32 v220, v221
  v_cmp_nle_f32 vcc, 0x30800000, v221
  v_cmp_nge_f32 s[30:31], s5, v221
  v_mul_f32 v44, v44, v220
  v_mul_f32 v45, v45, v220
  v_mul_f32 v46, v46, v220
  v_mul_f32 v47, v47, v220
  v_mul_f32 v48, v48, v220
  v_mul_f32 v49, v49, v220
  v_mul_f32 v50, v50, v220
  v_mul_f32 v51, v51, v220
  v_mul_f32 v52, v52, v220
  v_mul_f32 v53, v53, v220
  v_mul_f32 v54, v54, v220
  v_mul_f32 v55, v55, v220
  v_mul_f32 v56, v56, v220
  v_mul_f32 v57, v57, v220
  v_mul_f32 v58, v58, v220
  v_mul_f32 v59, v59, v220
  v_cvt_pk_bf16_f32 v108, v44, v45
  v_cvt_pk_bf16_f32 v109, v46, v47
  v_cvt_pk_bf16_f32 v110, v48, v49
  v_cvt_pk_bf16_f32 v111, v50, v51
  v_cvt_pk_bf16_f32 v112, v52, v53
  v_cvt_pk_bf16_f32 v113, v54, v55
  v_cvt_pk_bf16_f32 v114, v56, v57
  v_cvt_pk_bf16_f32 v115, v58, v59
  buffer_store_dwordx4 v[108:111], v2, s[24:27], s47 offen sc1
  buffer_store_dwordx4 v[112:115], v2, s[24:27], s47 offen offset:1024 sc1
  s_or_b64 vcc, vcc, s[30:31]
  s_cbranch_vccz attn_ok
  v_mov_b32 v4, 1
  ds_write_b32 v11, v4
attn_ok:
  s_waitcnt vmcnt(0) lgkmcnt(0)
  s_barrier
  ds_read_b32 v4, v11
  s_waitcnt lgkmcnt(0)
  v_readfirstlane_b32 s4, v4
  s_cmp_gt_u32 s4, s52
  s_cbranch_scc1 attn_fb
  s_cmp_eq_u32 s20, 0
  s_cbranch_scc0 sig3
  s_lshl_b32 s4, s21, 8
  s_add_u32 s4, s4, s59
  s_add_u32 s4, s4, 4096
  s_mov_b64 exec, 1
  v_mov_b32 v4, 1
  buffer_atomic_add v4, v1, s[24:27], s4 offen sc1
  s_mov_b64 exec, -1
sig3:
  s_cmp_eq_u32 s22, 7
  s_cbranch_scc1 idle
  s_lshl_b32 s44, s12, 15
  s_lshl_b32 s45, s13, 15
  s_lshl_b32 s4, s20, 13
  s_add_u32 s4, s4, s60
  s_add_u32 s44, s44, s4
  s_add_u32 s45, s45, s4
  s_cmp_eq_u32 s20, 0
  s_cbranch_scc0 wt4d
  s_lshl_b32 s4, s21, 8
  s_add_u32 s4, s4, s59
  s_add_u32 s4, s4, 4096
  s_mov_b32 s5, 0x8000
wt4:
  buffer_load_dword v4, v1, s[24:27], s4 offen sc1
  s_sub_u32 s5, s5, 1
  s_cbranch_scc1 wt4d
  s_waitcnt vmcnt(0)
  v_readfirstlane_b32 s6, v4
  s_cmp_lt_u32 s6, 16
  s_cbranch_scc1 wt4
wt4d:
  s_waitcnt lgkmcnt(0)
  s_barrier
  buffer_load_dwordx4 v[128:131], v2, s[24:27], s44 offen offset:0 sc1
  buffer_load_dwordx4 v[132:135], v2, s[24:27], s45 offen offset:0 sc1
  buffer_load_dwordx4 v[136:139], v2, s[24:27], s44 offen offset:1024 sc1
  buffer_load_dwordx4 v[140:143], v2, s[24:27], s45 offen offset:1024 sc1
  buffer_load_dwordx4 v[144:147], v2, s[24:27], s44 offen offset:2048 sc1
  buffer_load_dwordx4 v[148:151], v2, s[24:27], s45 offen offset:2048 sc1
  buffer_load_dwordx4 v[152:155], v2, s[24:27], s44 offen offset:3072 sc1
  buffer_load_dwordx4 v[156:159], v2, s[24:27], s45 offen offset:3072 sc1
  s_add_u32 s44, s44, 4096
  s_add_u32 s45, s45, 4096
  buffer_load_dwordx4 v[160:163], v2, s[24:27], s44 offen offset:0 sc1
  buffer_load_dwordx4 v[164:167], v2, s[24:27], s45 offen offset:0 sc1
  buffer_load_dwordx4 v[168:171], v2, s[24:27], s44 offen offset:1024 sc1
  buffer_load_dwordx4 v[172:175], v2, s[24:27], s45 offen offset:1024 sc1
  buffer_load_dwordx4 v[176:179], v2, s[24:27], s44 offen offset:2048 sc1
  buffer_load_dwordx4 v[180:183], v2, s[24:27], s45 offen offset:2048 sc1
  buffer_load_dwordx4 v[184:187], v2, s[24:27], s44 offen offset:3072 sc1
  buffer_load_dwordx4 v[188:191], v2, s[24:27], s45 offen offset:3072 sc1
  s_waitcnt vmcnt(14)
  v_mfma_f32_32x32x16_bf16 v[16:31], a[192:195], v[128:131], 0
  v_mfma_f32_32x32x16_bf16 v[32:47], a[192:195], v[132:135], 0
  v_mfma_f32_32x32x16_bf16 v[48:63], a[196:199], v[128:131], 0
  v_mfma_f32_32x32x16_bf16 v[64:79], a[196:199], v[132:135], 0
  s_waitcnt vmcnt(12)
  v_mfma_f32_32x32x16_bf16 v[16:31], a[200:203], v[136:139], v[16:31]
  v_mfma_f32_32x32x16_bf16 v[32:47], a[200:203], v[140:143], v[32:47]
  v_mfma_f32_32x32x16_bf16 v[48:63], a[204:207], v[136:139], v[48:63]
  v_mfma_f32_32x32x16_bf16 v[64:79], a[204:207], v[140:143], v[64:79]
  s_waitcnt vmcnt(10)
  v_mfma_f32_32x32x16_bf16 v[16:31], a[208:211], v[144:147], v[16:31]
  v_mfma_f32_32x32x16_bf16 v[32:47], a[208:211], v[148:151], v[32:47]
  v_mfma_f32_32x32x16_bf16 v[48:63], a[212:215], v[144:147], v[48:63]
  v_mfma_f32_32x32x16_bf16 v[64:79], a[212:215], v[148:151], v[64:79]
  s_waitcnt vmcnt(8)
  v_mfma_f32_32x32x16_bf16 v[16:31], a[216:219], v[152:155], v[16:31]
  v_mfma_f32_32x32x16_bf16 v[32:47], a[216:219], v[156:159], v[32:47]
  v_mfma_f32_32x32x16_bf16 v[48:63], a[220:223], v[152:155], v[48:63]
  v_mfma_f32_32x32x16_bf16 v[64:79], a[220:223], v[156:159], v[64:79]
  s_waitcnt vmcnt(6)
  v_mfma_f32_32x32x16_bf16 v[16:31], a[224:227], v[160:163], v[16:31]
  v_mfma_f32_32x32x16_bf16 v[32:47], a[224:227], v[164:167], v[32:47]
  v_mfma_f32_32x32x16_bf16 v[48:63], a[228:231], v[160:163], v[48:63]
  v_mfma_f32_32x32x16_bf16 v[64:79], a[228:231], v[164:167], v[64:79]
  s_waitcnt vmcnt(4)
  v_mfma_f32_32x32x16_bf16 v[16:31], a[232:235], v[168:171], v[16:31]
  v_mfma_f32_32x32x16_bf16 v[32:47], a[232:235], v[172:175], v[32:47]
  v_mfma_f32_32x32x16_bf16 v[48:63], a[236:239], v[168:171], v[48:63]
  v_mfma_f32_32x32x16_bf16 v[64:79], a[236:239], v[172:175], v[64:79]
  s_waitcnt vmcnt(2)
  v_mfma_f32_32x32x16_bf16 v[16:31], a[240:243], v[176:179], v[16:31]
  v_mfma_f32_32x32x16_bf16 v[32:47], a[240:243], v[180:183], v[32:47]
  v_mfma_f32_32x32x16_bf16 v[48:63], a[244:247], v[176:179], v[48:63]
  v_mfma_f32_32x32x16_bf16 v[64:79], a[244:247], v[180:183], v[64:79]
  s_waitcnt vmcnt(0)
  v_mfma_f32_32x32x16_bf16 v[16:31], a[248:251], v[184:187], v[16:31]
  v_mfma_f32_32x32x16_bf16 v[32:47], a[248:251], v[188:191], v[32:47]
  v_mfma_f32_32x32x16_bf16 v[48:63], a[252:255], v[184:187], v[48:63]
  v_mfma_f32_32x32x16_bf16 v[64:79], a[252:255], v[188:191], v[64:79]
  s_nop 7
  s_nop 3
  s_add_u32 s46, s53, 49152
  buffer_load_dwordx4 a[192:195], v2, s[24:27], s46 offen offset:0 sc1
  buffer_load_dwordx4 a[196:199], v2, s[24:27], s46 offen offset:1024 sc1
  buffer_load_dwordx4 a[200:203], v2, s[24:27], s46 offen offset:2048 sc1
  buffer_load_dwordx4 a[204:207], v2, s[24:27], s46 offen offset:3072 sc1
  s_add_u32 s46, s53, 53248
  buffer_load_dwordx4 a[208:211], v2, s[24:27], s46 offen offset:0 sc1
  buffer_load_dwordx4 a[212:215], v2, s[24:27], s46 offen offset:1024 sc1
  buffer_load_dwordx4 a[216:219], v2, s[24:27], s46 offen offset:2048 sc1
  buffer_load_dwordx4 a[220:223], v2, s[24:27], s46 offen offset:3072 sc1
  ds_write_b128 v6, v[32:35] offset:0
  ds_write_b128 v6, v[36:39] offset:1024
  ds_write_b128 v6, v[40:43] offset:2048
  ds_write_b128 v6, v[44:47] offset:3072
  ds_write_b128 v7, v[48:51] offset:0
  ds_write_b128 v7, v[52:55] offset:1024
  ds_write_b128 v7, v[56:59] offset:2048
  ds_write_b128 v7, v[60:63] offset:3072
  ds_write_b128 v8, v[64:67] offset:0
  ds_write_b128 v8, v[68:71] offset:1024
  ds_write_b128 v8, v[72:75] offset:2048
  ds_write_b128 v8, v[76:79] offset:3072
  s_waitcnt lgkmcnt(0)
  s_barrier
  ds_read_b128 v[80:83], v5 offset:0
  ds_read_b128 v[84:87], v5 offset:1024
  ds_read_b128 v[88:91], v5 offset:2048
  ds_read_b128 v[92:95], v5 offset:3072
  ds_read_b128 v[96:99], v5 offset:4096
  ds_read_b128 v[100:103], v5 offset:5120
  ds_read_b128 v[104:107], v5 offset:6144
  ds_read_b128 v[108:111], v5 offset:7168
  ds_read_b128 v[112:115], v5 offset:8192
  ds_read_b128 v[116:119], v5 offset:9216
  ds_read_b128 v[120:123], v5 offset:10240
  ds_read_b128 v[124:127], v5 offset:11264
  s_mul_i32 s54, s56, 4194304
  s_add_u32 s54, s54, 2097152
  s_mul_i32 s55, s56, 524288
  s_add_u32 s55, s55, 34865152
  v_lshlrev_b32 v32, 16, v248
  v_and_b32 v33, 0xffff0000, v248
  v_lshlrev_b32 v34, 16, v249
  v_and_b32 v35, 0xffff0000, v249
  v_lshlrev_b32 v36, 16, v250
  v_and_b32 v37, 0xffff0000, v250
  v_lshlrev_b32 v38, 16, v251
  v_and_b32 v39, 0xffff0000, v251
  v_lshlrev_b32 v40, 16, v252
  v_and_b32 v41, 0xffff0000, v252
  v_lshlrev_b32 v42, 16, v253
  v_and_b32 v43, 0xffff0000, v253
  v_lshlrev_b32 v44, 16, v254
  v_and_b32 v45, 0xffff0000, v254
  v_lshlrev_b32 v46, 16, v255
  v_and_b32 v47, 0xffff0000, v255
  v_add_f32 v16, v16, v32
  v_add_f32 v17, v17, v33
  v_add_f32 v18, v18, v34
  v_add_f32 v19, v19, v35
  v_add_f32 v20, v20, v36
  v_add_f32 v21, v21, v37
  v_add_f32 v22, v22, v38
  v_add_f32 v23, v23, v39
  v_add_f32 v24, v24, v40
  v_add_f32 v25, v25, v41
  v_add_f32 v26, v26, v42
  v_add_f32 v27, v27, v43
  v_add_f32 v28, v28, v44
  v_add_f32 v29, v29, v45
  v_add_f32 v30, v30, v46
  v_add_f32 v31, v31, v47
  s_waitcnt lgkmcnt(8)
  v_add_f32 v16, v16, v80
  v_add_f32 v17, v17, v81
  v_add_f32 v18, v18, v82
  v_add_f32 v19, v19, v83
  v_add_f32 v20, v20, v84
  v_add_f32 v21, v21, v85
  v_add_f32 v22, v22, v86
  v_add_f32 v23, v23, v87
  v_add_f32 v24, v24, v88
  v_add_f32 v25, v25, v89
  v_add_f32 v26, v26, v90
  v_add_f32 v27, v27, v91
  v_add_f32 v28, v28, v92
  v_add_f32 v29, v29, v93
  v_add_f32 v30, v30, v94
  v_add_f32 v31, v31, v95
  s_waitcnt lgkmcnt(4)
  v_add_f32 v16, v16, v96
  v_add_f32 v17, v17, v97
  v_add_f32 v18, v18, v98
  v_add_f32 v19, v19, v99
  v_add_f32 v20, v20, v100
  v_add_f32 v21, v21, v101
  v_add_f32 v22, v22, v102
  v_add_f32 v23, v23, v103
  v_add_f32 v24, v24, v104
  v_add_f32 v25, v25, v105
  v_add_f32 v26, v26, v106
  v_add_f32 v27, v27, v107
  v_add_f32 v28, v28, v108
  v_add_f32 v29, v29, v109
  v_add_f32 v30, v30, v110
  v_add_f32 v31, v31, v111
  s_waitcnt lgkmcnt(0)
  v_add_f32 v16, v16, v112
  v_add_f32 v17, v17, v113
  v_add_f32 v18, v18, v114
  v_add_f32 v19, v19, v115
  v_add_f32 v20, v20, v116
  v_add_f32 v21, v21, v117
  v_add_f32 v22, v22, v118
  v_add_f32 v23, v23, v119
  v_add_f32 v24, v24, v120
  v_add_f32 v25, v25, v121
  v_add_f32 v26, v26, v122
  v_add_f32 v27, v27, v123
  v_add_f32 v28, v28, v124
  v_add_f32 v29, v29, v125
  v_add_f32 v30, v30, v126
  v_add_f32 v31, v31, v127
  v_cvt_pk_bf16_f32 v248, v16, v17
  v_cvt_pk_bf16_f32 v249, v18, v19
  v_cvt_pk_bf16_f32 v250, v20, v21
  v_cvt_pk_bf16_f32 v251, v22, v23
  v_cvt_pk_bf16_f32 v252, v24, v25
  v_cvt_pk_bf16_f32 v253, v26, v27
  v_cvt_pk_bf16_f32 v254, v28, v29
  v_cvt_pk_bf16_f32 v255, v30, v31
  s_add_u32 s4, s49, s54
  buffer_store_dwordx4 v[248:251], v2, s[24:27], s4 offen sc1
  buffer_store_dwordx4 v[252:255], v2, s[24:27], s4 offen offset:1024 sc1
  v_add_f32 v32, v16, v17
  v_add_f32 v33, v18, v19
  v_mul_f32 v34, v16, v16
  v_mul_f32 v35, v17, v17
  v_fmac_f32 v34, v18, v18
  v_fmac_f32 v35, v19, v19
  v_add_f32 v32, v32, v20
  v_add_f32 v33, v33, v21
  v_fmac_f32 v34, v20, v20
  v_fmac_f32 v35, v21, v21
  v_add_f32 v32, v32, v22
  v_add_f32 v33, v33, v23
  v_fmac_f32 v34, v22, v22
  v_fmac_f32 v35, v23, v23
  v_add_f32 v32, v32, v24
  v_add_f32 v33, v33, v25
  v_fmac_f32 v34, v24, v24
  v_fmac_f32 v35, v25, v25
  v_add_f32 v32, v32, v26
  v_add_f32 v33, v33, v27
  v_fmac_f32 v34, v26, v26
  v_fmac_f32 v35, v27, v27
  v_add_f32 v32, v32, v28
  v_add_f32 v33, v33, v29
  v_fmac_f32 v34, v28, v28
  v_fmac_f32 v35, v29, v29
  v_add_f32 v32, v32, v30
  v_add_f32 v33, v33, v31
  v_fmac_f32 v34, v30, v30
  v_fmac_f32 v35, v31, v31
  v_add_f32 v32, v32, v33
  v_add_f32 v34, v34, v35
  s_lshl_b32 s4, s12, 12
  s_lshl_b32 s5, s14, 8
  v_permlane32_swap_b32 v32, v34
  s_add_u32 s4, s4, s5
  s_add_u32 s4, s4, s55
  s_nop 0
  v_add_f32 v32, v32, v34
  buffer_store_dword v32, v3, s[24:27], s4 offen sc1
  s_waitcnt vmcnt(0) lgkmcnt(0)
  s_barrier
  s_cmp_eq_u32 s20, 0
  s_cbranch_scc0 sig5
  s_lshl_b32 s4, s21, 8
  s_add_u32 s4, s4, s59
  s_add_u32 s4, s4, 8192
  s_mov_b64 exec, 1
  v_mov_b32 v4, 1
  buffer_atomic_add v4, v1, s[24:27], s4 offen sc1
  s_mov_b64 exec, -1
sig5:
  s_mul_i32 s41, s21, 114688
  s_add_u32 s41, s41, s54
  s_mul_i32 s38, s20, 14336
  s_add_u32 s51, s38, 57344
  s_add_u32 s50, s51, s41
  s_and_b32 s40, s20, 1
  s_mul_i32 s40, s40, 28672
  s_lshr_b32 s4, s20, 1
  s_lshl_b32 s4, s4, 11
  s_add_u32 s40, s40, s4
  s_add_u32 s41, s41, s40
  s_lshl_b32 s48, s20, 13
  s_add_u32 s48, s48, 114688
  v_add_u32 v10, s48, v2
  s_lshl_b32 s39, s21, 8
  s_add_u32 s39, s39, s59
  s_add_u32 s39, s39, 12288
  s_lshl_b32 s44, s10, 12
  s_add_u32 s44, s44, s55
  s_lshl_b32 s4, s20, 7
  v_and_b32 v12, 31, v0
  v_lshlrev_b32 v13, 2, v12
  v_add_u32 v13, 147456, v13
  v_add_u32 v14, s4, v13
  v_add_u32 v15, 57344, v2
  v_add_u32 v9, s38, v2
  s_mul_i32 s4, s21, 458752
  s_lshl_b32 s5, s11, 11
  s_add_u32 s4, s4, s5
  s_add_u32 s32, s4, s61
  s_add_u32 s33, s32, 114688
  s_add_u32 s34, s33, 114688
  s_add_u32 s35, s34, 114688
  s_mul_i32 s36, s14, 114688
  s_mul_i32 s37, s15, 114688
  s_mul_i32 s4, s20, 28672
  s_add_u32 s4, s4, 16777216
  s_add_u32 s36, s36, s4
  s_add_u32 s37, s37, s4
  s_cmp_eq_u32 s20, 0
  s_cbranch_scc0 wt6d
  s_lshl_b32 s4, s21, 8
  s_add_u32 s4, s4, s59
  s_add_u32 s4, s4, 8192
  s_mov_b32 s5, 0x8000
wt6:
  buffer_load_dword v4, v1, s[24:27], s4 offen sc1
  s_sub_u32 s5, s5, 1
  s_cbranch_scc1 wt6d
  s_waitcnt vmcnt(0)
  v_readfirstlane_b32 s6, v4
  s_cmp_lt_u32 s6, 14
  s_cbranch_scc1 wt6
wt6d:
  s_waitcnt lgkmcnt(0)
  s_barrier
  s_add_u32 m0, s40, 0
  s_add_u32 s45, s41, 0
  buffer_load_dwordx4 v2, s[24:27], s45 offen offset:0 sc1 lds
  buffer_load_dwordx4 v2, s[24:27], s45 offen offset:1024 sc1 lds
  s_add_u32 m0, s40, 4096
  s_add_u32 s45, s41, 4096
  buffer_load_dwordx4 v2, s[24:27], s45 offen offset:0 sc1 lds
  buffer_load_dwordx4 v2, s[24:27], s45 offen offset:1024 sc1 lds
  s_add_u32 m0, s40, 8192
  s_add_u32 s45, s41, 8192
  buffer_load_dwordx4 v2, s[24:27], s45 offen offset:0 sc1 lds
  buffer_load_dwordx4 v2, s[24:27], s45 offen offset:1024 sc1 lds
  s_waitcnt vmcnt(4)
  s_barrier
  ds_read_b128 v[16:19], v2 offset:0
  ds_read_b128 v[20:23], v2 offset:28672
  ds_read_b128 v[24:27], v2 offset:1024
  ds_read_b128 v[28:31], v2 offset:29696
  s_waitcnt lgkmcnt(2)
  v_mfma_f32_32x32x16_bf16 v[64:79], a[0:3], v[16:19], 0
  s_add_u32 m0, s40, 12288
  s_add_u32 s45, s41, 12288
  buffer_load_dwordx4 v2, s[24:27], s45 offen offset:0 sc1 lds
  v_mfma_f32_32x32x16_bf16 v[80:95], a[4:7], v[16:19], 0
  v_mfma_f32_32x32x16_bf16 v[96:111], a[0:3], v[20:23], 0
  buffer_load_dwordx4 v2, s[24:27], s45 offen offset:1024 sc1 lds
  v_mfma_f32_32x32x16_bf16 v[112:127], a[4:7], v[20:23], 0
  ds_read_b128 v[16:19], v2 offset:2048
  ds_read_b128 v[20:23], v2 offset:30720
  s_waitcnt lgkmcnt(2)
  v_mfma_f32_32x32x16_bf16 v[64:79], a[8:11], v[24:27], v[64:79]
  buffer_load_dword v40, v3, s[24:27], s44 offen offset:0 sc1
  v_mfma_f32_32x32x16_bf16 v[80:95], a[12:15], v[24:27], v[80:95]
  v_mfma_f32_32x32x16_bf16 v[96:111], a[8:11], v[28:31], v[96:111]
  buffer_load_dword v41, v3, s[24:27], s44 offen offset:256 sc1
  v_mfma_f32_32x32x16_bf16 v[112:127], a[12:15], v[28:31], v[112:127]
  ds_read_b128 v[24:27], v2 offset:3072
  ds_read_b128 v[28:31], v2 offset:31744
  s_waitcnt lgkmcnt(2)
  v_mfma_f32_32x32x16_bf16 v[64:79], a[16:19], v[16:19], v[64:79]
  buffer_load_dword v42, v3, s[24:27], s44 offen offset:512 sc1
  v_mfma_f32_32x32x16_bf16 v[80:95], a[20:23], v[16:19], v[80:95]
  v_mfma_f32_32x32x16_bf16 v[96:111], a[16:19], v[20:23], v[96:111]
  buffer_load_dword v43, v3, s[24:27], s44 offen offset:768 sc1
  v_mfma_f32_32x32x16_bf16 v[112:127], a[20:23], v[20:23], v[112:127]
  s_waitcnt vmcnt(8)
  s_barrier
  ds_read_b128 v[16:19], v2 offset:4096
  ds_read_b128 v[20:23], v2 offset:32768
  s_waitcnt lgkmcnt(2)
  v_mfma_f32_32x32x16_bf16 v[64:79], a[24:27], v[24:27], v[64:79]
  buffer_load_dword v44, v3, s[24:27], s44 offen offset:1024 sc1
  v_mfma_f32_32x32x16_bf16 v[80:95], a[28:31], v[24:27], v[80:95]
  buffer_load_dword v45, v3, s[24:27], s44 offen offset:1280 sc1
  v_mfma_f32_32x32x16_bf16 v[96:111], a[24:27], v[28:31], v[96:111]
  buffer_load_dword v46, v3, s[24:27], s44 offen offset:1536 sc1
  v_mfma_f32_32x32x16_bf16 v[112:127], a[28:31], v[28:31], v[112:127]
  ds_read_b128 v[24:27], v2 offset:5120
  ds_read_b128 v[28:31], v2 offset:33792
  s_waitcnt lgkmcnt(2)
  v_mfma_f32_32x32x16_bf16 v[64:79], a[32:35], v[16:19], v[64:79]
  s_add_u32 m0, s40, 16384
  s_add_u32 s45, s41, 16384
  buffer_load_dwordx4 v2, s[24:27], s45 offen offset:0 sc1 lds
  v_mfma_f32_32x32x16_bf16 v[80:95], a[36:39], v[16:19], v[80:95]
  v_mfma_f32_32x32x16_bf16 v[96:111], a[32:35], v[20:23], v[96:111]
  buffer_load_dwordx4 v2, s[24:27], s45 offen offset:1024 sc1 lds
  v_mfma_f32_32x32x16_bf16 v[112:127], a[36:39], v[20:23], v[112:127]
  ds_read_b128 v[16:19], v2 offset:6144
  ds_read_b128 v[20:23], v2 offset:34816
  s_waitcnt lgkmcnt(2)
  v_mfma_f32_32x32x16_bf16 v[64:79], a[40:43], v[24:27], v[64:79]
  buffer_load_dword v47, v3, s[24:27], s44 offen offset:1792 sc1
  v_mfma_f32_32x32x16_bf16 v[80:95], a[44:47], v[24:27], v[80:95]
  v_mfma_f32_32x32x16_bf16 v[96:111], a[40:43], v[28:31], v[96:111]
  buffer_load_dword v48, v3, s[24:27], s44 offen offset:2048 sc1
  v_mfma_f32_32x32x16_bf16 v[112:127], a[44:47], v[28:31], v[112:127]
  ds_read_b128 v[24:27], v2 offset:7168
  ds_read_b128 v[28:31], v2 offset:35840
  s_waitcnt lgkmcnt(2)
  v_mfma_f32_32x32x16_bf16 v[64:79], a[48:51], v[16:19], v[64:79]
  buffer_load_dword v49, v3, s[24:27], s44 offen offset:2304 sc1
  v_mfma_f32_32x32x16_bf16 v[80:95], a[52:55], v[16:19], v[80:95]
  v_mfma_f32_32x32x16_bf16 v[96:111], a[48:51], v[20:23], v[96:111]
  buffer_load_dword v50, v3, s[24:27], s44 offen offset:2560 sc1
  v_mfma_f32_32x32x16_bf16 v[112:127], a[52:55], v[20:23], v[112:127]
  s_waitcnt vmcnt(15)
  s_barrier
  ds_read_b128 v[16:19], v2 offset:8192
  ds_read_b128 v[20:23], v2 offset:36864
  s_waitcnt lgkmcnt(2)
  v_mfma_f32_32x32x16_bf16 v[64:79], a[56:59], v[24:27], v[64:79]
  buffer_load_dword v51, v3, s[24:27], s44 offen offset:2816 sc1
  v_mfma_f32_32x32x16_bf16 v[80:95], a[60:63], v[24:27], v[80:95]
  buffer_load_dword v52, v3, s[24:27], s44 offen offset:3072 sc1
  v_mfma_f32_32x32x16_bf16 v[96:111], a[56:59], v[28:31], v[96:111]
  buffer_load_dword v53, v3, s[24:27], s44 offen offset:3328 sc1
  v_mfma_f32_32x32x16_bf16 v[112:127], a[60:63], v[28:31], v[112:127]
  ds_read_b128 v[24:27], v2 offset:9216
  ds_read_b128 v[28:31], v2 offset:37888
  s_waitcnt lgkmcnt(2)
  v_mfma_f32_32x32x16_bf16 v[64:79], a[64:67], v[16:19], v[64:79]
  s_add_u32 m0, s40, 20480
  s_add_u32 s45, s41, 20480
  buffer_load_dwordx4 v2, s[24:27], s45 offen offset:0 sc1 lds
  v_mfma_f32_32x32x16_bf16 v[80:95], a[68:71], v[16:19], v[80:95]
  v_mfma_f32_32x32x16_bf16 v[96:111], a[64:67], v[20:23], v[96:111]
  buffer_load_dwordx4 v2, s[24:27], s45 offen offset:1024 sc1 lds
  v_mfma_f32_32x32x16_bf16 v[112:127], a[68:71], v[20:23], v[112:127]
  ds_read_b128 v[16:19], v2 offset:10240
  ds_read_b128 v[20:23], v2 offset:38912
  s_waitcnt lgkmcnt(2)
  v_mfma_f32_32x32x16_bf16 v[64:79], a[72:75], v[24:27], v[64:79]
  s_add_u32 m0, s51, 0
  s_add_u32 s46, s50, 0
  buffer_load_dwordx4 v2, s[24:27], s46 offen offset:0 sc1 lds
  v_mfma_f32_32x32x16_bf16 v[80:95], a[76:79], v[24:27], v[80:95]
  buffer_load_dwordx4 v2, s[24:27], s46 offen offset:1024 sc1 lds
  v_mfma_f32_32x32x16_bf16 v[96:111], a[72:75], v[28:31], v[96:111]
  buffer_load_dwordx4 v2, s[24:27], s46 offen offset:2048 sc1 lds
  v_mfma_f32_32x32x16_bf16 v[112:127], a[76:79], v[28:31], v[112:127]
  ds_read_b128 v[24:27], v2 offset:11264
  ds_read_b128 v[28:31], v2 offset:39936
  s_waitcnt lgkmcnt(2)
  v_mfma_f32_32x32x16_bf16 v[64:79], a[80:83], v[16:19], v[64:79]
  buffer_load_dwordx4 v2, s[24:27], s46 offen offset:3072 sc1 lds
  v_mfma_f32_32x32x16_bf16 v[80:95], a[84:87], v[16:19], v[80:95]
  v_mfma_f32_32x32x16_bf16 v[96:111], a[80:83], v[20:23], v[96:111]
  s_add_u32 m0, s51, 4096
  s_add_u32 s46, s50, 4096
  buffer_load_dwordx4 v2, s[24:27], s46 offen offset:0 sc1 lds
  v_mfma_f32_32x32x16_bf16 v[112:127], a[84:87], v[20:23], v[112:127]
  s_waitcnt vmcnt(23)
  s_barrier
  ds_read_b128 v[16:19], v2 offset:12288
  ds_read_b128 v[20:23], v2 offset:40960
  s_waitcnt lgkmcnt(2)
  v_mfma_f32_32x32x16_bf16 v[64:79], a[88:91], v[24:27], v[64:79]
  buffer_load_dwordx4 v2, s[24:27], s46 offen offset:1024 sc1 lds
  v_mfma_f32_32x32x16_bf16 v[80:95], a[92:95], v[24:27], v[80:95]
  buffer_load_dwordx4 v2, s[24:27], s46 offen offset:2048 sc1 lds
  v_mfma_f32_32x32x16_bf16 v[96:111], a[88:91], v[28:31], v[96:111]
  buffer_load_dwordx4 v2, s[24:27], s46 offen offset:3072 sc1 lds
  v_mfma_f32_32x32x16_bf16 v[112:127], a[92:95], v[28:31], v[112:127]
  ds_read_b128 v[24:27], v2 offset:13312
  ds_read_b128 v[28:31], v2 offset:41984
  s_waitcnt lgkmcnt(2)
  v_mfma_f32_32x32x16_bf16 v[64:79], a[96:99], v[16:19], v[64:79]
  s_add_u32 m0, s40, 24576
  s_add_u32 s45, s41, 24576
  buffer_load_dwordx4 v2, s[24:27], s45 offen offset:0 sc1 lds
  v_mfma_f32_32x32x16_bf16 v[80:95], a[100:103], v[16:19], v[80:95]
  v_mfma_f32_32x32x16_bf16 v[96:111], a[96:99], v[20:23], v[96:111]
  buffer_load_dwordx4 v2, s[24:27], s45 offen offset:1024 sc1 lds
  v_mfma_f32_32x32x16_bf16 v[112:127], a[100:103], v[20:23], v[112:127]
  ds_read_b128 v[16:19], v2 offset:14336
  ds_read_b128 v[20:23], v2 offset:43008
  s_waitcnt lgkmcnt(2)
  v_mfma_f32_32x32x16_bf16 v[64:79], a[104:107], v[24:27], v[64:79]
  s_add_u32 m0, s51, 8192
  s_add_u32 s46, s50, 8192
  buffer_load_dwordx4 v2, s[24:27], s46 offen offset:0 sc1 lds
  v_mfma_f32_32x32x16_bf16 v[80:95], a[108:111], v[24:27], v[80:95]
  v_mfma_f32_32x32x16_bf16 v[96:111], a[104:107], v[28:31], v[96:111]
  buffer_load_dwordx4 v2, s[24:27], s46 offen offset:1024 sc1 lds
  v_mfma_f32_32x32x16_bf16 v[112:127], a[108:111], v[28:31], v[112:127]
  ds_read_b128 v[24:27], v2 offset:15360
  ds_read_b128 v[28:31], v2 offset:44032
  s_waitcnt lgkmcnt(2)
  v_mfma_f32_32x32x16_bf16 v[64:79], a[112:115], v[16:19], v[64:79]
  buffer_load_dwordx4 v2, s[24:27], s46 offen offset:2048 sc1 lds
  v_mfma_f32_32x32x16_bf16 v[80:95], a[116:119], v[16:19], v[80:95]
  v_mfma_f32_32x32x16_bf16 v[96:111], a[112:115], v[20:23], v[96:111]
  buffer_load_dwordx4 v2, s[24:27], s46 offen offset:3072 sc1 lds
  v_mfma_f32_32x32x16_bf16 v[112:127], a[116:119], v[20:23], v[112:127]
  s_waitcnt vmcnt(23)
  s_barrier
  ds_read_b128 v[16:19], v2 offset:16384
  ds_read_b128 v[20:23], v2 offset:45056
  s_waitcnt lgkmcnt(2)
  v_mfma_f32_32x32x16_bf16 v[64:79], a[120:123], v[24:27], v[64:79]
  s_add_u32 m0, s51, 12288
  s_add_u32 s46, s50, 12288
  buffer_load_dwordx4 v2, s[24:27], s46 offen offset:0 sc1 lds
  v_mfma_f32_32x32x16_bf16 v[80:95], a[124:127], v[24:27], v[80:95]
  v_mfma_f32_32x32x16_bf16 v[96:111], a[120:123], v[28:31], v[96:111]
  buffer_load_dwordx4 v2, s[24:27], s46 offen offset:1024 sc1 lds
  v_mfma_f32_32x32x16_bf16 v[112:127], a[124:127], v[28:31], v[112:127]
  ds_read_b128 v[24:27], v2 offset:17408
  ds_read_b128 v[28:31], v2 offset:46080
  s_waitcnt lgkmcnt(2)
  v_mfma_f32_32x32x16_bf16 v[64:79], a[128:131], v[16:19], v[64:79]
  s_add_u32 s46, s36, 0
  buffer_load_dwordx4 a[224:227], v2, s[24:27], s46 offen offset:0 sc1
  v_mfma_f32_32x32x16_bf16 v[80:95], a[132:135], v[16:19], v[80:95]
  v_mfma_f32_32x32x16_bf16 v[96:111], a[128:131], v[20:23], v[96:111]
  s_add_u32 s47, s37, 0
  buffer_load_dwordx4 a[228:231], v2, s[24:27], s47 offen offset:0 sc1
  v_mfma_f32_32x32x16_bf16 v[112:127], a[132:135], v[20:23], v[112:127]
  s_waitcnt vmcnt(20)
  v_add_f32 v40, v40, v47
  v_add_f32 v41, v41, v48
  v_add_f32 v42, v42, v49
  v_add_f32 v43, v43, v50
  v_add_f32 v44, v44, v51
  v_add_f32 v45, v45, v52
  v_add_f32 v46, v46, v53
  v_add_f32 v40, v40, v41
  v_add_f32 v42, v42, v43
  v_add_f32 v44, v44, v45
  v_add_f32 v40, v40, v46
  v_add_f32 v42, v42, v44
  v_add_f32 v40, v40, v42
  v_mul_f32 v40, 0x3b124925, v40
  v_mov_b32 v41, v40
  s_nop 1
  v_permlane32_swap_b32 v40, v41
  s_nop 1
  v_fma_f32 v40, -v40, v40, v41
  v_max_f32 v40, 0, v40
  v_add_f32 v40, 0x3727c5ac, v40
  v_rsq_f32 v40, v40
  s_nop 0
  ds_write_b32 v14, v40
  ds_read_b128 v[16:19], v2 offset:18432
  ds_read_b128 v[20:23], v2 offset:47104
  s_waitcnt lgkmcnt(2)
  v_mfma_f32_32x32x16_bf16 v[64:79], a[136:139], v[24:27], v[64:79]
  buffer_load_dwordx4 a[232:235], v2, s[24:27], s46 offen offset:1024 sc1
  v_mfma_f32_32x32x16_bf16 v[80:95], a[140:143], v[24:27], v[80:95]
  v_mfma_f32_32x32x16_bf16 v[96:111], a[136:139], v[28:31], v[96:111]
  buffer_load_dwordx4 a[236:239], v2, s[24:27], s47 offen offset:1024 sc1
  v_mfma_f32_32x32x16_bf16 v[112:127], a[140:143], v[28:31], v[112:127]
  ds_read_b128 v[24:27], v2 offset:19456
  ds_read_b128 v[28:31], v2 offset:48128
  s_waitcnt lgkmcnt(2)
  v_mfma_f32_32x32x16_bf16 v[64:79], a[144:147], v[16:19], v[64:79]
  buffer_load_dwordx4 a[240:243], v2, s[24:27], s46 offen offset:2048 sc1
  v_mfma_f32_32x32x16_bf16 v[80:95], a[148:151], v[16:19], v[80:95]
  v_mfma_f32_32x32x16_bf16 v[96:111], a[144:147], v[20:23], v[96:111]
  buffer_load_dwordx4 a[244:247], v2, s[24:27], s47 offen offset:2048 sc1
  v_mfma_f32_32x32x16_bf16 v[112:127], a[148:151], v[20:23], v[112:127]
  s_waitcnt vmcnt(22)
  s_waitcnt lgkmcnt(0)
  s_barrier
  ds_read_b128 v[16:19], v2 offset:20480
  ds_read_b128 v[20:23], v2 offset:49152
  s_waitcnt lgkmcnt(2)
  v_mfma_f32_32x32x16_bf16 v[64:79], a[152:155], v[24:27], v[64:79]
  buffer_load_dwordx4 a[248:251], v2, s[24:27], s46 offen offset:3072 sc1
  v_mfma_f32_32x32x16_bf16 v[80:95], a[156:159], v[24:27], v[80:95]
  v_mfma_f32_32x32x16_bf16 v[96:111], a[152:155], v[28:31], v[96:111]
  buffer_load_dwordx4 a[252:255], v2, s[24:27], s47 offen offset:3072 sc1
  v_mfma_f32_32x32x16_bf16 v[112:127], a[156:159], v[28:31], v[112:127]
  ds_read_b128 v[24:27], v2 offset:21504
  ds_read_b128 v[28:31], v2 offset:50176
  s_waitcnt lgkmcnt(2)
  v_mfma_f32_32x32x16_bf16 v[64:79], a[160:163], v[16:19], v[64:79]
  s_add_u32 m0, s48, 0
  s_add_u32 s45, s36, 17408
  buffer_load_dwordx4 v2, s[24:27], s45 offen offset:0 sc1 lds
  v_mfma_f32_32x32x16_bf16 v[80:95], a[164:167], v[16:19], v[80:95]
  v_mfma_f32_32x32x16_bf16 v[96:111], a[160:163], v[20:23], v[96:111]
  buffer_load_dwordx4 v2, s[24:27], s45 offen offset:1024 sc1 lds
  v_mfma_f32_32x32x16_bf16 v[112:127], a[164:167], v[20:23], v[112:127]
  ds_read_b32 v244, v13 offset:0
  ds_read_b32 v245, v13 offset:128
  ds_read_b32 v246, v13 offset:256
  ds_read_b32 v247, v13 offset:384
  ds_read_b128 v[16:19], v2 offset:22528
  ds_read_b128 v[20:23], v2 offset:51200
  s_waitcnt lgkmcnt(2)
  v_mfma_f32_32x32x16_bf16 v[64:79], a[168:171], v[24:27], v[64:79]
  buffer_load_dwordx4 v2, s[24:27], s45 offen offset:2048 sc1 lds
  v_mfma_f32_32x32x16_bf16 v[80:95], a[172:175], v[24:27], v[80:95]
  v_mfma_f32_32x32x16_bf16 v[96:111], a[168:171], v[28:31], v[96:111]
  buffer_load_dwordx4 v2, s[24:27], s45 offen offset:3072 sc1 lds
  v_mfma_f32_32x32x16_bf16 v[112:127], a[172:175], v[28:31], v[112:127]
  ds_read_b128 v[24:27], v2 offset:23552
  ds_read_b128 v[28:31], v2 offset:52224
  s_waitcnt lgkmcnt(2)
  v_mfma_f32_32x32x16_bf16 v[64:79], a[176:179], v[16:19], v[64:79]
  s_add_u32 m0, s48, 4096
  s_add_u32 s45, s37, 17408
  buffer_load_dwordx4 v2, s[24:27], s45 offen offset:0 sc1 lds
  buffer_load_dwordx4 v2, s[24:27], s45 offen offset:1024 sc1 lds
  v_mfma_f32_32x32x16_bf16 v[80:95], a[180:183], v[16:19], v[80:95]
  v_rcp_f32 v240, v244
  v_mul_f32 v244, 0xbfb8aa3b, v244
  v_mfma_f32_32x32x16_bf16 v[96:111], a[176:179], v[20:23], v[96:111]
  v_rcp_f32 v241, v245
  v_mul_f32 v245, 0xbfb8aa3b, v245
  v_rcp_f32 v242, v246
  v_mul_f32 v246, 0xbfb8aa3b, v246
  v_mfma_f32_32x32x16_bf16 v[112:127], a[180:183], v[20:23], v[112:127]
  v_rcp_f32 v243, v247
  v_mul_f32 v247, 0xbfb8aa3b, v247
  s_waitcnt vmcnt(20)
  s_barrier
  ds_read_b128 v[16:19], v2 offset:24576
  ds_read_b128 v[20:23], v2 offset:53248
  s_waitcnt lgkmcnt(2)
  v_mfma_f32_32x32x16_bf16 v[64:79], a[184:187], v[24:27], v[64:79]
  buffer_load_dwordx4 v2, s[24:27], s45 offen offset:2048 sc1 lds
  v_mfma_f32_32x32x16_bf16 v[80:95], a[188:191], v[24:27], v[80:95]
  v_mfma_f32_32x32x16_bf16 v[96:111], a[184:187], v[28:31], v[96:111]
  buffer_load_dwordx4 v2, s[24:27], s45 offen offset:3072 sc1 lds
  v_mfma_f32_32x32x16_bf16 v[112:127], a[188:191], v[28:31], v[112:127]
  ds_read_b128 v[24:27], v2 offset:25600
  ds_read_b128 v[28:31], v2 offset:54272
  s_waitcnt lgkmcnt(2)
  v_mfma_f32_32x32x16_bf16 v[64:79], a[192:195], v[16:19], v[64:79]
  v_mfma_f32_32x32x16_bf16 v[80:95], a[196:199], v[16:19], v[80:95]
  v_mfma_f32_32x32x16_bf16 v[96:111], a[192:195], v[20:23], v[96:111]
  v_mfma_f32_32x32x16_bf16 v[112:127], a[196:199], v[20:23], v[112:127]
  ds_read_b128 v[16:19], v2 offset:26624
  ds_read_b128 v[20:23], v2 offset:55296
  s_waitcnt lgkmcnt(2)
  v_mfma_f32_32x32x16_bf16 v[64:79], a[200:203], v[24:27], v[64:79]
  v_mfma_f32_32x32x16_bf16 v[80:95], a[204:207], v[24:27], v[80:95]
  v_mfma_f32_32x32x16_bf16 v[96:111], a[200:203], v[28:31], v[96:111]
  v_mfma_f32_32x32x16_bf16 v[112:127], a[204:207], v[28:31], v[112:127]
  ds_read_b128 v[24:27], v2 offset:27648
  ds_read_b128 v[28:31], v2 offset:56320
  s_waitcnt lgkmcnt(2)
  v_mfma_f32_32x32x16_bf16 v[64:79], a[208:211], v[16:19], v[64:79]
  v_mfma_f32_32x32x16_bf16 v[80:95], a[212:215], v[16:19], v[80:95]
  v_mfma_f32_32x32x16_bf16 v[96:111], a[208:211], v[20:23], v[96:111]
  v_mfma_f32_32x32x16_bf16 v[112:127], a[212:215], v[20:23], v[112:127]
  s_waitcnt lgkmcnt(0)
  s_waitcnt vmcnt(16)
  s_barrier
  ds_read_b128 v[224:227], v15 offset:0
  ds_read_b128 v[228:231], v15 offset:1024
  v_mfma_f32_32x32x16_bf16 v[64:79], a[216:219], v[24:27], v[64:79]
  v_mfma_f32_32x32x16_bf16 v[80:95], a[220:223], v[24:27], v[80:95]
  v_mfma_f32_32x32x16_bf16 v[96:111], a[216:219], v[28:31], v[96:111]
  v_mfma_f32_32x32x16_bf16 v[112:127], a[220:223], v[28:31], v[112:127]
  ds_read_b128 v[232:235], v15 offset:2048
  ds_read_b128 v[236:239], v15 offset:3072
  s_waitcnt lgkmcnt(2)
  v_mfma_f32_32x32x16_bf16 v[128:143], a[0:3], v[224:227], 0
  v_mfma_f32_32x32x16_bf16 v[144:159], a[4:7], v[224:227], 0
  s_nop 7
  v_mul_f32 v64, v244, v64
  v_mul_f32 v65, v244, v65
  v_mul_f32 v66, v244, v66
  v_mul_f32 v67, v244, v67
  v_mul_f32 v68, v244, v68
  v_mul_f32 v69, v244, v69
  v_mul_f32 v70, v244, v70
  v_mfma_f32_32x32x16_bf16 v[128:143], a[8:11], v[228:231], v[128:143]
  s_add_u32 m0, s38, 0
  s_add_u32 s45, s36, 21504
  buffer_load_dwordx4 v2, s[24:27], s45 offen offset:0 sc1 lds
  v_mul_f32 v71, v244, v71
  v_exp_f32 v64, v64
  v_exp_f32 v65, v65
  v_mfma_f32_32x32x16_bf16 v[144:159], a[12:15], v[228:231], v[144:159]
  v_exp_f32 v66, v66
  v_exp_f32 v67, v67
  v_exp_f32 v68, v68
  ds_read_b128 v[224:227], v15 offset:4096
  ds_read_b128 v[228:231], v15 offset:5120
  s_waitcnt lgkmcnt(2)
  v_mfma_f32_32x32x16_bf16 v[128:143], a[16:19], v[232:235], v[128:143]
  buffer_load_dwordx4 v2, s[24:27], s45 offen offset:1024 sc1 lds
  v_exp_f32 v69, v69
  v_exp_f32 v70, v70
  v_exp_f32 v71, v71
  v_mfma_f32_32x32x16_bf16 v[144:159], a[20:23], v[232:235], v[144:159]
  v_fma_f32 v64, v64, v240, v240
  v_fma_f32 v65, v65, v240, v240
  v_fma_f32 v66, v66, v240, v240
  v_mfma_f32_32x32x16_bf16 v[128:143], a[24:27], v[236:239], v[128:143]
  v_fma_f32 v67, v67, v240, v240
  buffer_load_dwordx4 v2, s[24:27], s45 offen offset:2048 sc1 lds
  v_fma_f32 v68, v68, v240, v240
  v_fma_f32 v69, v69, v240, v240
  v_mfma_f32_32x32x16_bf16 v[144:159], a[28:31], v[236:239], v[144:159]
  v_fma_f32 v70, v70, v240, v240
  v_fma_f32 v71, v71, v240, v240
  v_rcp_f32 v64, v64
  ds_read_b128 v[232:235], v15 offset:6144
  ds_read_b128 v[236:239], v15 offset:7168
  s_waitcnt lgkmcnt(2)
  v_mfma_f32_32x32x16_bf16 v[128:143], a[32:35], v[224:227], v[128:143]
  v_rcp_f32 v65, v65
  buffer_load_dwordx4 v2, s[24:27], s45 offen offset:3072 sc1 lds
  v_rcp_f32 v66, v66
  v_rcp_f32 v67, v67
  v_mfma_f32_32x32x16_bf16 v[144:159], a[36:39], v[224:227], v[144:159]
  v_rcp_f32 v68, v68
  v_rcp_f32 v69, v69
  v_rcp_f32 v70, v70
  v_rcp_f32 v71, v71
  v_mfma_f32_32x32x16_bf16 v[128:143], a[40:43], v[228:231], v[128:143]
  v_mul_f32 v80, v80, v64
  s_add_u32 m0, s38, 4096
  s_add_u32 s45, s36, 25600
  buffer_load_dwordx4 v2, s[24:27], s45 offen offset:0 sc1 lds
  v_mul_f32 v81, v81, v65
  v_mul_f32 v82, v82, v66
  v_mfma_f32_32x32x16_bf16 v[144:159], a[44:47], v[228:231], v[144:159]
  v_mul_f32 v83, v83, v67
  v_mul_f32 v84, v84, v68
  v_mul_f32 v85, v85, v69
  ds_read_b128 v[224:227], v15 offset:8192
  ds_read_b128 v[228:231], v15 offset:9216
  s_waitcnt lgkmcnt(2)
  v_mfma_f32_32x32x16_bf16 v[128:143], a[48:51], v[232:235], v[128:143]
  v_mul_f32 v86, v86, v70
  buffer_load_dwordx4 v2, s[24:27], s45 offen offset:1024 sc1 lds
  v_mul_f32 v87, v87, v71
  v_cvt_pk_bf16_f32 v192, v80, v81
  v_mfma_f32_32x32x16_bf16 v[144:159], a[52:55], v[232:235], v[144:159]
  v_cvt_pk_bf16_f32 v193, v82, v83
  v_cvt_pk_bf16_f32 v194, v84, v85
  v_cvt_pk_bf16_f32 v195, v86, v87
  v_mfma_f32_32x32x16_bf16 v[128:143], a[56:59], v[236:239], v[128:143]
  buffer_store_dwordx4 v[192:195], v2, s[24:27], s32 offen offset:0 sc1
  buffer_load_dwordx4 v2, s[24:27], s45 offen offset:2048 sc1 lds
  v_mul_f32 v72, v244, v72
  v_mul_f32 v73, v244, v73
  v_mfma_f32_32x32x16_bf16 v[144:159], a[60:63], v[236:239], v[144:159]
  v_mul_f32 v74, v244, v74
  v_mul_f32 v75, v244, v75
  v_mul_f32 v76, v244, v76
  ds_read_b128 v[232:235], v15 offset:10240
  ds_read_b128 v[236:239], v15 offset:11264
  s_waitcnt lgkmcnt(2)
  v_mfma_f32_32x32x16_bf16 v[128:143], a[64:67], v[224:227], v[128:143]
  v_mul_f32 v77, v244, v77
  v_mul_f32 v78, v244, v78
  s_add_u32 m0, s38, 7168
  s_add_u32 s45, s37, 21504
  buffer_load_dwordx4 v2, s[24:27], s45 offen offset:0 sc1 lds
  v_mul_f32 v79, v244, v79
  v_mfma_f32_32x32x16_bf16 v[144:159], a[68:71], v[224:227], v[144:159]
  v_exp_f32 v72, v72
  v_exp_f32 v73, v73
  v_exp_f32 v74, v74
  v_mfma_f32_32x32x16_bf16 v[128:143], a[72:75], v[228:231], v[128:143]
  v_exp_f32 v75, v75
  v_exp_f32 v76, v76
  buffer_load_dwordx4 v2, s[24:27], s45 offen offset:1024 sc1 lds
  v_exp_f32 v77, v77
  v_mfma_f32_32x32x16_bf16 v[144:159], a[76:79], v[228:231], v[144:159]
  v_exp_f32 v78, v78
  v_exp_f32 v79, v79
  v_fma_f32 v72, v72, v240, v240
  v_fma_f32 v73, v73, v240, v240
  ds_read_b128 v[224:227], v15 offset:12288
  ds_read_b128 v[228:231], v15 offset:13312
  s_waitcnt lgkmcnt(2)
  v_mfma_f32_32x32x16_bf16 v[128:143], a[80:83], v[232:235], v[128:143]
  v_fma_f32 v74, v74, v240, v240
  v_fma_f32 v75, v75, v240, v240
  buffer_load_dwordx4 v2, s[24:27], s45 offen offset:2048 sc1 lds
  v_fma_f32 v76, v76, v240, v240
  v_mfma_f32_32x32x16_bf16 v[144:159], a[84:87], v[232:235], v[144:159]
  v_fma_f32 v77, v77, v240, v240
  v_fma_f32 v78, v78, v240, v240
  v_fma_f32 v79, v79, v240, v240
  v_mfma_f32_32x32x16_bf16 v[128:143], a[88:91], v[236:239], v[128:143]
  v_rcp_f32 v72, v72
  v_rcp_f32 v73, v73
  buffer_load_dwordx4 v2, s[24:27], s45 offen offset:3072 sc1 lds
  v_rcp_f32 v74, v74
  v_mfma_f32_32x32x16_bf16 v[144:159], a[92:95], v[236:239], v[144:159]
  v_rcp_f32 v75, v75
  v_rcp_f32 v76, v76
  v_rcp_f32 v77, v77
  ds_read_b128 v[232:235], v15 offset:14336
  ds_read_b128 v[236:239], v15 offset:15360
  s_waitcnt lgkmcnt(2)
  v_mfma_f32_32x32x16_bf16 v[128:143], a[96:99], v[224:227], v[128:143]
  v_rcp_f32 v78, v78
  v_rcp_f32 v79, v79
  v_mul_f32 v88, v88, v72
  s_add_u32 m0, s38, 11264
  s_add_u32 s45, s37, 25600
  buffer_load_dwordx4 v2, s[24:27], s45 offen offset:0 sc1 lds
  v_mfma_f32_32x32x16_bf16 v[144:159], a[100:103], v[224:227], v[144:159]
  v_mul_f32 v89, v89, v73
  v_mul_f32 v90, v90, v74
  v_mul_f32 v91, v91, v75
  v_mfma_f32_32x32x16_bf16 v[128:143], a[104:107], v[228:231], v[128:143]
  v_mul_f32 v92, v92, v76
  v_mul_f32 v93, v93, v77
  v_mul_f32 v94, v94, v78
  buffer_load_dwordx4 v2, s[24:27], s45 offen offset:1024 sc1 lds
  v_mfma_f32_32x32x16_bf16 v[144:159], a[108:111], v[228:231], v[144:159]
  v_mul_f32 v95, v95, v79
  v_cvt_pk_bf16_f32 v196, v88, v89
  v_cvt_pk_bf16_f32 v197, v90, v91
  v_cvt_pk_bf16_f32 v198, v92, v93
  ds_read_b128 v[224:227], v15 offset:16384
  ds_read_b128 v[228:231], v15 offset:17408
  s_waitcnt lgkmcnt(2)
  v_mfma_f32_32x32x16_bf16 v[128:143], a[112:115], v[232:235], v[128:143]
  v_cvt_pk_bf16_f32 v199, v94, v95
  buffer_store_dwordx4 v[196:199], v2, s[24:27], s32 offen offset:1024 sc1
  buffer_load_dwordx4 v2, s[24:27], s45 offen offset:2048 sc1 lds
  v_mul_f32 v96, v245, v96
  v_mfma_f32_32x32x16_bf16 v[144:159], a[116:119], v[232:235], v[144:159]
  v_mul_f32 v97, v245, v97
  v_mul_f32 v98, v245, v98
  v_mul_f32 v99, v245, v99
  v_mfma_f32_32x32x16_bf16 v[128:143], a[120:123], v[236:239], v[128:143]
  v_mul_f32 v100, v245, v100
  v_mul_f32 v101, v245, v101
  v_mul_f32 v102, v245, v102
  v_mul_f32 v103, v245, v103
  v_mfma_f32_32x32x16_bf16 v[144:159], a[124:127], v[236:239], v[144:159]
  v_exp_f32 v96, v96
  v_exp_f32 v97, v97
  v_exp_f32 v98, v98
  ds_read_b128 v[232:235], v15 offset:18432
  ds_read_b128 v[236:239], v15 offset:19456
  s_waitcnt lgkmcnt(2)
  v_mfma_f32_32x32x16_bf16 v[128:143], a[128:131], v[224:227], v[128:143]
  v_exp_f32 v99, v99
  s_add_u32 s46, s36, 4096
  buffer_load_dwordx4 v[64:67], v2, s[24:27], s46 offen offset:0 sc1
  v_exp_f32 v100, v100
  v_exp_f32 v101, v101
  v_mfma_f32_32x32x16_bf16 v[144:159], a[132:135], v[224:227], v[144:159]
  v_exp_f32 v102, v102
  v_exp_f32 v103, v103
  v_fma_f32 v96, v96, v241, v241
  v_mfma_f32_32x32x16_bf16 v[128:143], a[136:139], v[228:231], v[128:143]
  v_fma_f32 v97, v97, v241, v241
  v_fma_f32 v98, v98, v241, v241
  v_fma_f32 v99, v99, v241, v241
  v_fma_f32 v100, v100, v241, v241
  v_mfma_f32_32x32x16_bf16 v[144:159], a[140:143], v[228:231], v[144:159]
  v_fma_f32 v101, v101, v241, v241
  v_fma_f32 v102, v102, v241, v241
  s_add_u32 s47, s37, 4096
  buffer_load_dwordx4 v[68:71], v2, s[24:27], s47 offen offset:0 sc1
  ds_read_b128 v[224:227], v15 offset:20480
  ds_read_b128 v[228:231], v15 offset:21504
  s_waitcnt lgkmcnt(2)
  v_mfma_f32_32x32x16_bf16 v[128:143], a[144:147], v[232:235], v[128:143]
  v_fma_f32 v103, v103, v241, v241
  v_rcp_f32 v96, v96
  v_rcp_f32 v97, v97
  v_rcp_f32 v98, v98
  v_mfma_f32_32x32x16_bf16 v[144:159], a[148:151], v[232:235], v[144:159]
  v_rcp_f32 v99, v99
  v_rcp_f32 v100, v100
  v_rcp_f32 v101, v101
  v_rcp_f32 v102, v102
  v_mfma_f32_32x32x16_bf16 v[128:143], a[152:155], v[236:239], v[128:143]
  v_rcp_f32 v103, v103
  v_mul_f32 v112, v112, v96
  v_mul_f32 v113, v113, v97
  buffer_load_dwordx4 v[72:75], v2, s[24:27], s46 offen offset:1024 sc1
  v_mfma_f32_32x32x16_bf16 v[144:159], a[156:159], v[236:239], v[144:159]
  v_mul_f32 v114, v114, v98
  v_mul_f32 v115, v115, v99
  v_mul_f32 v116, v116, v100
  ds_read_b128 v[232:235], v15 offset:22528
  ds_read_b128 v[236:239], v15 offset:23552
  s_waitcnt lgkmcnt(2)
  v_mfma_f32_32x32x16_bf16 v[128:143], a[160:163], v[224:227], v[128:143]
  v_mul_f32 v117, v117, v101
  v_mul_f32 v118, v118, v102
  v_mul_f32 v119, v119, v103
  v_cvt_pk_bf16_f32 v200, v112, v113
  v_mfma_f32_32x32x16_bf16 v[144:159], a[164:167], v[224:227], v[144:159]
  v_cvt_pk_bf16_f32 v201, v114, v115
  v_cvt_pk_bf16_f32 v202, v116, v117
  v_cvt_pk_bf16_f32 v203, v118, v119
  v_mfma_f32_32x32x16_bf16 v[128:143], a[168:171], v[228:231], v[128:143]
  buffer_store_dwordx4 v[200:203], v2, s[24:27], s33 offen offset:0 sc1
  buffer_load_dwordx4 v[76:79], v2, s[24:27], s47 offen offset:1024 sc1
  v_mul_f32 v104, v245, v104
  v_mul_f32 v105, v245, v105
  v_mfma_f32_32x32x16_bf16 v[144:159], a[172:175], v[228:231], v[144:159]
  v_mul_f32 v106, v245, v106
  v_mul_f32 v107, v245, v107
  v_mul_f32 v108, v245, v108
  ds_read_b128 v[224:227], v15 offset:24576
  ds_read_b128 v[228:231], v15 offset:25600
  s_waitcnt lgkmcnt(2)
  v_mfma_f32_32x32x16_bf16 v[128:143], a[176:179], v[232:235], v[128:143]
  v_mul_f32 v109, v245, v109
  v_mul_f32 v110, v245, v110
  v_mul_f32 v111, v245, v111
  v_exp_f32 v104, v104
  v_mfma_f32_32x32x16_bf16 v[144:159], a[180:183], v[232:235], v[144:159]
  v_exp_f32 v105, v105
  v_exp_f32 v106, v106
  v_exp_f32 v107, v107
  v_mfma_f32_32x32x16_bf16 v[128:143], a[184:187], v[236:239], v[128:143]
  buffer_load_dwordx4 v[80:83], v2, s[24:27], s46 offen offset:2048 sc1
  v_exp_f32 v108, v108
  v_exp_f32 v109, v109
  v_exp_f32 v110, v110
  v_mfma_f32_32x32x16_bf16 v[144:159], a[188:191], v[236:239], v[144:159]
  v_exp_f32 v111, v111
  v_fma_f32 v104, v104, v241, v241
  v_fma_f32 v105, v105, v241, v241
  v_fma_f32 v106, v106, v241, v241
  ds_read_b128 v[232:235], v15 offset:26624
  ds_read_b128 v[236:239], v15 offset:27648
  s_waitcnt lgkmcnt(2)
  v_mfma_f32_32x32x16_bf16 v[128:143], a[192:195], v[224:227], v[128:143]
  v_fma_f32 v107, v107, v241, v241
  v_fma_f32 v108, v108, v241, v241
  v_fma_f32 v109, v109, v241, v241
  v_fma_f32 v110, v110, v241, v241
  v_mfma_f32_32x32x16_bf16 v[144:159], a[196:199], v[224:227], v[144:159]
  buffer_load_dwordx4 v[84:87], v2, s[24:27], s47 offen offset:2048 sc1
  v_fma_f32 v111, v111, v241, v241
  v_rcp_f32 v104, v104
  v_mfma_f32_32x32x16_bf16 v[128:143], a[200:203], v[228:231], v[128:143]
  v_rcp_f32 v105, v105
  v_rcp_f32 v106, v106
  v_rcp_f32 v107, v107
  v_rcp_f32 v108, v108
  v_mfma_f32_32x32x16_bf16 v[144:159], a[204:207], v[228:231], v[144:159]
  v_rcp_f32 v109, v109
  v_rcp_f32 v110, v110
  v_rcp_f32 v111, v111
  ds_read_b128 v[224:227], v15 offset:28672
  ds_read_b128 v[228:231], v15 offset:29696
  s_waitcnt lgkmcnt(2)
  v_mfma_f32_32x32x16_bf16 v[128:143], a[208:211], v[232:235], v[128:143]
  v_mul_f32 v120, v120, v104
  v_mul_f32 v121, v121, v105
  buffer_load_dwordx4 v[88:91], v2, s[24:27], s46 offen offset:3072 sc1
  v_mul_f32 v122, v122, v106
  v_mfma_f32_32x32x16_bf16 v[144:159], a[212:215], v[232:235], v[144:159]
  v_mul_f32 v123, v123, v107
  v_mul_f32 v124, v124, v108
  v_mul_f32 v125, v125, v109
  v_mfma_f32_32x32x16_bf16 v[128:143], a[216:219], v[236:239], v[128:143]
  v_mul_f32 v126, v126, v110
  v_mul_f32 v127, v127, v111
  v_cvt_pk_bf16_f32 v204, v120, v121
  v_cvt_pk_bf16_f32 v205, v122, v123
  v_mfma_f32_32x32x16_bf16 v[144:159], a[220:223], v[236:239], v[144:159]
  v_cvt_pk_bf16_f32 v206, v124, v125
  v_cvt_pk_bf16_f32 v207, v126, v127
  buffer_store_dwordx4 v[204:207], v2, s[24:27], s33 offen offset:1024 sc1
  buffer_load_dwordx4 v[92:95], v2, s[24:27], s47 offen offset:3072 sc1
  s_lshl_b32 s44, s21, 2
  s_add_u32 s44, s44, s23
  s_mul_i32 s44, s44, 114688
  s_mul_i32 s4, s20, 28672
  s_add_u32 s4, s4, s61
  s_add_u32 s44, s44, s4
  ds_read_b128 v[232:235], v15 offset:30720
  ds_read_b128 v[236:239], v15 offset:31744
  s_waitcnt lgkmcnt(2)
  v_mfma_f32_32x32x16_bf16 v[160:175], a[0:3], v[224:227], 0
  s_nop 7
  v_mul_f32 v128, v246, v128
  v_mul_f32 v129, v246, v129
  v_mfma_f32_32x32x16_bf16 v[160:175], a[8:11], v[228:231], v[160:175]
  v_mul_f32 v130, v246, v130
  v_mul_f32 v131, v246, v131
  v_mul_f32 v132, v246, v132
  ds_read_b128 v[224:227], v15 offset:32768
  ds_read_b128 v[228:231], v15 offset:33792
  s_waitcnt lgkmcnt(2)
  v_mfma_f32_32x32x16_bf16 v[160:175], a[16:19], v[232:235], v[160:175]
  v_mul_f32 v133, v246, v133
  v_mul_f32 v134, v246, v134
  v_mul_f32 v135, v246, v135
  s_add_u32 s46, s36, 8192
  buffer_load_dwordx4 v[96:99], v2, s[24:27], s46 offen offset:0 sc1
  v_mfma_f32_32x32x16_bf16 v[160:175], a[24:27], v[236:239], v[160:175]
  v_exp_f32 v128, v128
  v_exp_f32 v129, v129
  ds_read_b128 v[232:235], v15 offset:34816
  ds_read_b128 v[236:239], v15 offset:35840
  s_waitcnt lgkmcnt(2)
  v_mfma_f32_32x32x16_bf16 v[160:175], a[32:35], v[224:227], v[160:175]
  v_exp_f32 v130, v130
  v_exp_f32 v131, v131
  v_exp_f32 v132, v132
  s_add_u32 s47, s37, 8192
  buffer_load_dwordx4 v[100:103], v2, s[24:27], s47 offen offset:0 sc1
  v_mfma_f32_32x32x16_bf16 v[160:175], a[40:43], v[228:231], v[160:175]
  v_exp_f32 v133, v133
  v_exp_f32 v134, v134
  v_exp_f32 v135, v135
  ds_read_b128 v[224:227], v15 offset:36864
  ds_read_b128 v[228:231], v15 offset:37888
  s_waitcnt lgkmcnt(2)
  v_mfma_f32_32x32x16_bf16 v[160:175], a[48:51], v[232:235], v[160:175]
  v_fma_f32 v128, v128, v242, v242
  v_fma_f32 v129, v129, v242, v242
  v_fma_f32 v130, v130, v242, v242
  v_mfma_f32_32x32x16_bf16 v[160:175], a[56:59], v[236:239], v[160:175]
  v_fma_f32 v131, v131, v242, v242
  v_fma_f32 v132, v132, v242, v242
  buffer_load_dwordx4 v[104:107], v2, s[24:27], s46 offen offset:1024 sc1
  ds_read_b128 v[232:235], v15 offset:38912
  ds_read_b128 v[236:239], v15 offset:39936
  s_waitcnt lgkmcnt(2)
  v_mfma_f32_32x32x16_bf16 v[160:175], a[64:67], v[224:227], v[160:175]
  v_fma_f32 v133, v133, v242, v242
  v_fma_f32 v134, v134, v242, v242
  v_fma_f32 v135, v135, v242, v242
  v_mfma_f32_32x32x16_bf16 v[160:175], a[72:75], v[228:231], v[160:175]
  v_rcp_f32 v128, v128
  v_rcp_f32 v129, v129
  v_rcp_f32 v130, v130
  buffer_load_dwordx4 v[108:111], v2, s[24:27], s47 offen offset:1024 sc1
  ds_read_b128 v[224:227], v15 offset:40960
  ds_read_b128 v[228:231], v15 offset:41984
  s_waitcnt lgkmcnt(2)
  v_mfma_f32_32x32x16_bf16 v[160:175], a[80:83], v[232:235], v[160:175]
  v_rcp_f32 v131, v131
  v_rcp_f32 v132, v132
  v_rcp_f32 v133, v133
  v_mfma_f32_32x32x16_bf16 v[160:175], a[88:91], v[236:239], v[160:175]
  v_rcp_f32 v134, v134
  v_rcp_f32 v135, v135
  ds_read_b128 v[232:235], v15 offset:43008
  ds_read_b128 v[236:239], v15 offset:44032
  s_waitcnt lgkmcnt(2)
  v_mfma_f32_32x32x16_bf16 v[160:175], a[96:99], v[224:227], v[160:175]
  v_mul_f32 v144, v144, v128
  v_mul_f32 v145, v145, v129
  v_mul_f32 v146, v146, v130
  buffer_load_dwordx4 v[112:115], v2, s[24:27], s46 offen offset:2048 sc1
  v_mfma_f32_32x32x16_bf16 v[160:175], a[104:107], v[228:231], v[160:175]
  v_mul_f32 v147, v147, v131
  v_mul_f32 v148, v148, v132
  v_mul_f32 v149, v149, v133
  ds_read_b128 v[224:227], v15 offset:45056
  ds_read_b128 v[228:231], v15 offset:46080
  s_waitcnt lgkmcnt(2)
  v_mfma_f32_32x32x16_bf16 v[160:175], a[112:115], v[232:235], v[160:175]
  v_mul_f32 v150, v150, v134
  v_mul_f32 v151, v151, v135
  buffer_load_dwordx4 v[116:119], v2, s[24:27], s47 offen offset:2048 sc1
  v_mfma_f32_32x32x16_bf16 v[160:175], a[120:123], v[236:239], v[160:175]
  v_cvt_pk_bf16_f32 v208, v144, v145
  v_cvt_pk_bf16_f32 v209, v146, v147
  v_cvt_pk_bf16_f32 v210, v148, v149
  ds_read_b128 v[232:235], v15 offset:47104
  ds_read_b128 v[236:239], v15 offset:48128
  s_waitcnt lgkmcnt(2)
  v_mfma_f32_32x32x16_bf16 v[160:175], a[128:131], v[224:227], v[160:175]
  s_waitcnt vmcnt(7)
  s_barrier
  s_cmp_eq_u32 s20, 0
  s_cbranch_scc0 sig7
  s_lshl_b32 s4, s21, 8
  s_add_u32 s4, s4, s59
  s_add_u32 s4, s4, 12416
  s_mov_b64 exec, 1
  v_mov_b32 v4, 1
  buffer_atomic_add v4, v1, s[24:27], s4 offen sc1
  s_mov_b64 exec, -1
sig7:
  v_cvt_pk_bf16_f32 v211, v150, v151
  buffer_store_dwordx4 v[208:211], v2, s[24:27], s34 offen offset:0 sc1
  v_mul_f32 v136, v246, v136
  v_mfma_f32_32x32x16_bf16 v[160:175], a[136:139], v[228:231], v[160:175]
  v_mul_f32 v137, v246, v137
  v_mul_f32 v138, v246, v138
  v_mul_f32 v139, v246, v139
  buffer_load_dwordx4 v[120:123], v2, s[24:27], s46 offen offset:3072 sc1
  ds_read_b128 v[224:227], v15 offset:49152
  ds_read_b128 v[228:231], v15 offset:50176
  s_waitcnt lgkmcnt(2)
  v_mfma_f32_32x32x16_bf16 v[160:175], a[144:147], v[232:235], v[160:175]
  v_mul_f32 v140, v246, v140
  v_mul_f32 v141, v246, v141
  v_mfma_f32_32x32x16_bf16 v[160:175], a[152:155], v[236:239], v[160:175]
  v_mul_f32 v142, v246, v142
  v_mul_f32 v143, v246, v143
  v_exp_f32 v136, v136
  buffer_load_dwordx4 v[124:127], v2, s[24:27], s47 offen offset:3072 sc1
  ds_read_b128 v[232:235], v15 offset:51200
  ds_read_b128 v[236:239], v15 offset:52224
  s_waitcnt lgkmcnt(2)
  v_mfma_f32_32x32x16_bf16 v[160:175], a[160:163], v[224:227], v[160:175]
  v_exp_f32 v137, v137
  v_exp_f32 v138, v138
  v_exp_f32 v139, v139
  v_mfma_f32_32x32x16_bf16 v[160:175], a[168:171], v[228:231], v[160:175]
  v_exp_f32 v140, v140
  v_exp_f32 v141, v141
  v_exp_f32 v142, v142
  s_add_u32 s46, s36, 12288
  buffer_load_dwordx4 a[0:3], v2, s[24:27], s46 offen offset:0 sc1
  ds_read_b128 v[224:227], v15 offset:53248
  ds_read_b128 v[228:231], v15 offset:54272
  s_waitcnt lgkmcnt(2)
  v_mfma_f32_32x32x16_bf16 v[160:175], a[176:179], v[232:235], v[160:175]
  v_exp_f32 v143, v143
  v_fma_f32 v136, v136, v242, v242
  v_mfma_f32_32x32x16_bf16 v[160:175], a[184:187], v[236:239], v[160:175]
  v_fma_f32 v137, v137, v242, v242
  v_fma_f32 v138, v138, v242, v242
  v_fma_f32 v139, v139, v242, v242
  ds_read_b128 v[232:235], v15 offset:55296
  ds_read_b128 v[236:239], v15 offset:56320
  s_waitcnt lgkmcnt(2)
  v_mfma_f32_32x32x16_bf16 v[160:175], a[192:195], v[224:227], v[160:175]
  v_fma_f32 v140, v140, v242, v242
  v_fma_f32 v141, v141, v242, v242
  v_fma_f32 v142, v142, v242, v242
  s_add_u32 s47, s37, 12288
  buffer_load_dwordx4 a[8:11], v2, s[24:27], s47 offen offset:0 sc1
  ds_read_b128 a[80:83], v10 offset:0
  v_mfma_f32_32x32x16_bf16 v[160:175], a[200:203], v[228:231], v[160:175]
  v_fma_f32 v143, v143, v242, v242
  v_rcp_f32 v136, v136
  ds_read_b128 a[88:91], v10 offset:4096
  ds_read_b128 v[224:227], v15 offset:28672
  ds_read_b128 v[228:231], v15 offset:29696
  s_waitcnt lgkmcnt(4)
  v_mfma_f32_32x32x16_bf16 v[160:175], a[208:211], v[232:235], v[160:175]
  v_rcp_f32 v137, v137
  v_rcp_f32 v138, v138
  v_rcp_f32 v139, v139
  buffer_load_dwordx4 a[16:19], v2, s[24:27], s46 offen offset:1024 sc1
  ds_read_b128 a[96:99], v10 offset:1024
  v_mfma_f32_32x32x16_bf16 v[160:175], a[216:219], v[236:239], v[160:175]
  v_rcp_f32 v140, v140
  v_rcp_f32 v141, v141
  v_rcp_f32 v142, v142
  ds_read_b128 a[104:107], v10 offset:5120
  ds_read_b128 v[232:235], v15 offset:30720
  ds_read_b128 v[236:239], v15 offset:31744
  s_waitcnt lgkmcnt(4)
  v_mfma_f32_32x32x16_bf16 v[176:191], a[4:7], v[224:227], 0
  v_rcp_f32 v143, v143
  v_mul_f32 v152, v152, v136
  v_mul_f32 v153, v153, v137
  ds_read_b128 a[112:115], v10 offset:2048
  v_mfma_f32_32x32x16_bf16 v[176:191], a[12:15], v[228:231], v[176:191]
  v_mul_f32 v154, v154, v138
  v_mul_f32 v155, v155, v139
  buffer_load_dwordx4 a[24:27], v2, s[24:27], s47 offen offset:1024 sc1
  ds_read_b128 a[120:123], v10 offset:6144
  ds_read_b128 v[224:227], v15 offset:32768
  ds_read_b128 v[228:231], v15 offset:33792
  s_waitcnt lgkmcnt(4)
  v_mfma_f32_32x32x16_bf16 v[176:191], a[20:23], v[232:235], v[176:191]
  v_mul_f32 v156, v156, v140
  v_mul_f32 v157, v157, v141
  v_mul_f32 v158, v158, v142
  ds_read_b128 a[128:131], v10 offset:3072
  v_mfma_f32_32x32x16_bf16 v[176:191], a[28:31], v[236:239], v[176:191]
  v_mul_f32 v159, v159, v143
  v_cvt_pk_bf16_f32 v212, v152, v153
  v_cvt_pk_bf16_f32 v213, v154, v155
  buffer_load_dwordx4 a[32:35], v2, s[24:27], s46 offen offset:2048 sc1
  ds_read_b128 a[136:139], v10 offset:7168
  ds_read_b128 v[232:235], v15 offset:34816
  ds_read_b128 v[236:239], v15 offset:35840
  s_waitcnt lgkmcnt(4)
  v_mfma_f32_32x32x16_bf16 v[176:191], a[36:39], v[224:227], v[176:191]
  v_cvt_pk_bf16_f32 v214, v156, v157
  v_cvt_pk_bf16_f32 v215, v158, v159
  buffer_store_dwordx4 v[212:215], v2, s[24:27], s34 offen offset:1024 sc1
  ds_read_b128 a[144:147], v9 offset:0
  v_mfma_f32_32x32x16_bf16 v[176:191], a[44:47], v[228:231], v[176:191]
  v_mul_f32 v160, v247, v160
  v_mul_f32 v161, v247, v161
  ds_read_b128 a[152:155], v9 offset:7168
  ds_read_b128 v[224:227], v15 offset:36864
  ds_read_b128 v[228:231], v15 offset:37888
  s_waitcnt lgkmcnt(4)
  v_mfma_f32_32x32x16_bf16 v[176:191], a[52:55], v[232:235], v[176:191]
  v_mul_f32 v162, v247, v162
  v_mul_f32 v163, v247, v163
  v_mul_f32 v164, v247, v164
  buffer_load_dwordx4 a[40:43], v2, s[24:27], s47 offen offset:2048 sc1
  ds_read_b128 a[160:163], v9 offset:1024
  v_mfma_f32_32x32x16_bf16 v[176:191], a[60:63], v[236:239], v[176:191]
  v_mul_f32 v165, v247, v165
  v_mul_f32 v166, v247, v166
  v_mul_f32 v167, v247, v167
  ds_read_b128 a[168:171], v9 offset:8192
  ds_read_b128 v[232:235], v15 offset:38912
  ds_read_b128 v[236:239], v15 offset:39936
  s_waitcnt lgkmcnt(4)
  v_mfma_f32_32x32x16_bf16 v[176:191], a[68:71], v[224:227], v[176:191]
  v_exp_f32 v160, v160
  v_exp_f32 v161, v161
  v_exp_f32 v162, v162
  buffer_load_dwordx4 a[48:51], v2, s[24:27], s46 offen offset:3072 sc1
  ds_read_b128 a[176:179], v9 offset:2048
  v_mfma_f32_32x32x16_bf16 v[176:191], a[76:79], v[228:231], v[176:191]
  v_exp_f32 v163, v163
  v_exp_f32 v164, v164
  ds_read_b128 a[184:187], v9 offset:9216
  ds_read_b128 v[224:227], v15 offset:40960
  ds_read_b128 v[228:231], v15 offset:41984
  s_waitcnt lgkmcnt(4)
  v_mfma_f32_32x32x16_bf16 v[176:191], a[84:87], v[232:235], v[176:191]
  v_exp_f32 v165, v165
  v_exp_f32 v166, v166
  v_exp_f32 v167, v167
  ds_read_b128 a[192:195], v9 offset:3072
  v_mfma_f32_32x32x16_bf16 v[176:191], a[92:95], v[236:239], v[176:191]
  v_fma_f32 v160, v160, v243, v243
  v_fma_f32 v161, v161, v243, v243
  v_fma_f32 v162, v162, v243, v243
  buffer_load_dwordx4 a[56:59], v2, s[24:27], s47 offen offset:3072 sc1
  ds_read_b128 a[200:203], v9 offset:10240
  ds_read_b128 v[232:235], v15 offset:43008
  ds_read_b128 v[236:239], v15 offset:44032
  s_waitcnt lgkmcnt(4)
  v_mfma_f32_32x32x16_bf16 v[176:191], a[100:103], v[224:227], v[176:191]
  v_fma_f32 v163, v163, v243, v243
  v_fma_f32 v164, v164, v243, v243
  v_fma_f32 v165, v165, v243, v243
  ds_read_b128 a[208:211], v9 offset:4096
  v_mfma_f32_32x32x16_bf16 v[176:191], a[108:111], v[228:231], v[176:191]
  v_fma_f32 v166, v166, v243, v243
  v_fma_f32 v167, v167, v243, v243
  v_rcp_f32 v160, v160
  s_add_u32 s46, s36, 16384
  buffer_load_dwordx4 a[64:67], v2, s[24:27], s46 offen offset:0 sc1
  ds_read_b128 a[216:219], v9 offset:11264
  ds_read_b128 v[224:227], v15 offset:45056
  ds_read_b128 v[228:231], v15 offset:46080
  s_waitcnt lgkmcnt(4)
  v_mfma_f32_32x32x16_bf16 v[176:191], a[116:119], v[232:235], v[176:191]
  v_rcp_f32 v161, v161
  v_rcp_f32 v162, v162
  ds_read_b128 a[4:7], v9 offset:5120
  v_mfma_f32_32x32x16_bf16 v[176:191], a[124:127], v[236:239], v[176:191]
  v_rcp_f32 v163, v163
  v_rcp_f32 v164, v164
  v_rcp_f32 v165, v165
  s_add_u32 s47, s37, 16384
  buffer_load_dwordx4 a[72:75], v2, s[24:27], s47 offen offset:0 sc1
  ds_read_b128 a[12:15], v9 offset:12288
  ds_read_b128 v[232:235], v15 offset:47104
  ds_read_b128 v[236:239], v15 offset:48128
  s_waitcnt lgkmcnt(4)
  v_mfma_f32_32x32x16_bf16 v[176:191], a[132:135], v[224:227], v[176:191]
  v_rcp_f32 v166, v166
  v_rcp_f32 v167, v167
  v_mul_f32 v168, v247, v168
  ds_read_b128 a[20:23], v9 offset:6144
  v_mfma_f32_32x32x16_bf16 v[176:191], a[140:143], v[228:231], v[176:191]
  v_mul_f32 v169, v247, v169
  v_mul_f32 v170, v247, v170
  v_mul_f32 v171, v247, v171
  ds_read_b128 a[28:31], v9 offset:13312
  ds_read_b128 v[224:227], v15 offset:49152
  ds_read_b128 v[228:231], v15 offset:50176
  s_waitcnt lgkmcnt(4)
  v_mfma_f32_32x32x16_bf16 v[176:191], a[148:151], v[232:235], v[176:191]
  v_mul_f32 v172, v247, v172
  v_mul_f32 v173, v247, v173
  v_mfma_f32_32x32x16_bf16 v[176:191], a[156:159], v[236:239], v[176:191]
  v_mul_f32 v174, v247, v174
  v_mul_f32 v175, v247, v175
  v_exp_f32 v168, v168
  ds_read_b128 v[232:235], v15 offset:51200
  ds_read_b128 v[236:239], v15 offset:52224
  s_waitcnt lgkmcnt(2)
  v_mfma_f32_32x32x16_bf16 v[176:191], a[164:167], v[224:227], v[176:191]
  v_exp_f32 v169, v169
  v_exp_f32 v170, v170
  v_exp_f32 v171, v171
  v_mfma_f32_32x32x16_bf16 v[176:191], a[172:175], v[228:231], v[176:191]
  v_exp_f32 v172, v172
  v_exp_f32 v173, v173
  v_exp_f32 v174, v174
  ds_read_b128 v[224:227], v15 offset:53248
  ds_read_b128 v[228:231], v15 offset:54272
  s_waitcnt lgkmcnt(2)
  v_mfma_f32_32x32x16_bf16 v[176:191], a[180:183], v[232:235], v[176:191]
  buffer_load_dword v13, v1, s[24:27], s39 offen offset:128 sc1
  v_exp_f32 v175, v175
  v_fma_f32 v168, v168, v243, v243
  v_fma_f32 v169, v169, v243, v243
  v_mfma_f32_32x32x16_bf16 v[176:191], a[188:191], v[236:239], v[176:191]
  v_fma_f32 v170, v170, v243, v243
  v_fma_f32 v171, v171, v243, v243
  ds_read_b128 v[232:235], v15 offset:55296
  ds_read_b128 v[236:239], v15 offset:56320
  s_waitcnt lgkmcnt(2)
  v_mfma_f32_32x32x16_bf16 v[176:191], a[196:199], v[224:227], v[176:191]
  v_fma_f32 v172, v172, v243, v243
  v_fma_f32 v173, v173, v243, v243
  v_fma_f32 v174, v174, v243, v243
  v_mfma_f32_32x32x16_bf16 v[176:191], a[204:207], v[228:231], v[176:191]
  v_fma_f32 v175, v175, v243, v243
  v_rcp_f32 v168, v168
  v_rcp_f32 v169, v169
  s_waitcnt lgkmcnt(0)
  v_mfma_f32_32x32x16_bf16 v[176:191], a[212:215], v[232:235], v[176:191]
  v_rcp_f32 v170, v170
  v_rcp_f32 v171, v171
  v_rcp_f32 v172, v172
  v_mfma_f32_32x32x16_bf16 v[176:191], a[220:223], v[236:239], v[176:191]
  v_rcp_f32 v173, v173
  v_rcp_f32 v174, v174
  v_rcp_f32 v175, v175
  s_waitcnt lgkmcnt(0)
  s_lshr_b32 s4, s20, 1
  s_lshl_b32 s4, s4, 15
  s_lshl_b32 s5, s20, 12
  s_add_u32 s5, s5, 65536
  s_add_u32 s6, s4, s5
  v_add_u32 v9, s6, v2
  s_xor_b32 s4, s4, 32768
  s_add_u32 s6, s4, s5
  v_add_u32 v10, s6, v2
  s_lshl_b32 s4, s20, 14
  s_add_u32 s4, s4, 65536
  v_add_u32 v12, s4, v2
  s_nop 7
  v_mul_f32 v176, v176, v160
  v_mul_f32 v177, v177, v161
  v_mul_f32 v178, v178, v162
  v_mul_f32 v179, v179, v163
  v_mul_f32 v180, v180, v164
  v_mul_f32 v181, v181, v165
  v_mul_f32 v182, v182, v166
  v_mul_f32 v183, v183, v167
  v_cvt_pk_bf16_f32 v216, v176, v177
  v_cvt_pk_bf16_f32 v217, v178, v179
  v_cvt_pk_bf16_f32 v218, v180, v181
  v_cvt_pk_bf16_f32 v219, v182, v183
  buffer_store_dwordx4 v[216:219], v2, s[24:27], s35 offen offset:0 sc1
  v_mul_f32 v184, v184, v168
  v_mul_f32 v185, v185, v169
  v_mul_f32 v186, v186, v170
  v_mul_f32 v187, v187, v171
  v_mul_f32 v188, v188, v172
  v_mul_f32 v189, v189, v173
  v_mul_f32 v190, v190, v174
  v_mul_f32 v191, v191, v175
  v_cvt_pk_bf16_f32 v220, v184, v185
  v_cvt_pk_bf16_f32 v221, v186, v187
  v_cvt_pk_bf16_f32 v222, v188, v189
  v_cvt_pk_bf16_f32 v223, v190, v191
  buffer_store_dwordx4 v[220:223], v2, s[24:27], s35 offen offset:1024 sc1
  s_waitcnt vmcnt(2)
  s_mov_b32 s5, 0x8000
  s_branch pollAc
pollA:
  buffer_load_dword v13, v1, s[24:27], s39 offen offset:128 sc1
  s_waitcnt vmcnt(0)
pollAc:
  v_readfirstlane_b32 s6, v13
  s_sub_u32 s5, s5, 1
  s_cbranch_scc1 pollAd
  s_cmp_lt_u32 s6, 14
  s_cbranch_scc1 pollA
pollAd:
  s_add_u32 s45, s44, 0
  buffer_load_dwordx4 v[16:19], v2, s[24:27], s45 offen offset:0 sc1
  buffer_load_dwordx4 v[20:23], v2, s[24:27], s45 offen offset:1024 sc1
  buffer_load_dwordx4 v[24:27], v2, s[24:27], s45 offen offset:2048 sc1
  buffer_load_dwordx4 v[28:31], v2, s[24:27], s45 offen offset:3072 sc1
  s_add_u32 s45, s44, 4096
  buffer_load_dwordx4 v[32:35], v2, s[24:27], s45 offen offset:0 sc1
  buffer_load_dwordx4 v[36:39], v2, s[24:27], s45 offen offset:1024 sc1
  buffer_load_dwordx4 v[40:43], v2, s[24:27], s45 offen offset:2048 sc1
  buffer_load_dwordx4 v[44:47], v2, s[24:27], s45 offen offset:3072 sc1
  s_add_u32 s45, s44, 8192
  buffer_load_dwordx4 v[48:51], v2, s[24:27], s45 offen offset:0 sc1
  buffer_load_dwordx4 v[52:55], v2, s[24:27], s45 offen offset:1024 sc1
  s_waitcnt vmcnt(10)
  s_barrier
  s_cmp_eq_u32 s20, 0
  s_cbranch_scc0 sig8
  s_lshl_b32 s4, s21, 8
  s_add_u32 s4, s4, s59
  s_add_u32 s4, s4, 12288
  s_mov_b64 exec, 1
  v_mov_b32 v4, 1
  buffer_atomic_add v4, v1, s[24:27], s4 offen sc1
  s_mov_b64 exec, -1
sig8:
  s_waitcnt vmcnt(9)
  v_mfma_f32_32x32x16_bf16 v[128:143], a[224:227], v[16:19], 0
  buffer_load_dwordx4 v[56:59], v2, s[24:27], s45 offen offset:2048 sc1
  v_mfma_f32_32x32x16_bf16 v[144:159], a[228:231], v[16:19], 0
  s_waitcnt vmcnt(9)
  v_mfma_f32_32x32x16_bf16 v[128:143], a[232:235], v[20:23], v[128:143]
  buffer_load_dwordx4 v[60:63], v2, s[24:27], s45 offen offset:3072 sc1
  v_mfma_f32_32x32x16_bf16 v[144:159], a[236:239], v[20:23], v[144:159]
  s_waitcnt vmcnt(9)
  v_mfma_f32_32x32x16_bf16 v[128:143], a[240:243], v[24:27], v[128:143]
  s_add_u32 s45, s44, 12288
  buffer_load_dwordx4 v[16:19], v2, s[24:27], s45 offen offset:0 sc1
  v_mfma_f32_32x32x16_bf16 v[144:159], a[244:247], v[24:27], v[144:159]
  s_waitcnt vmcnt(9)
  v_mfma_f32_32x32x16_bf16 v[128:143], a[248:251], v[28:31], v[128:143]
  buffer_load_dwordx4 v[20:23], v2, s[24:27], s45 offen offset:1024 sc1
  v_mfma_f32_32x32x16_bf16 v[144:159], a[252:255], v[28:31], v[144:159]
  s_waitcnt vmcnt(9)
  v_mfma_f32_32x32x16_bf16 v[128:143], v[64:67], v[32:35], v[128:143]
  buffer_load_dwordx4 v[24:27], v2, s[24:27], s45 offen offset:2048 sc1
  v_mfma_f32_32x32x16_bf16 v[144:159], v[68:71], v[32:35], v[144:159]
  s_waitcnt vmcnt(9)
  v_mfma_f32_32x32x16_bf16 v[128:143], v[72:75], v[36:39], v[128:143]
  buffer_load_dwordx4 v[28:31], v2, s[24:27], s45 offen offset:3072 sc1
  v_mfma_f32_32x32x16_bf16 v[144:159], v[76:79], v[36:39], v[144:159]
  s_waitcnt vmcnt(9)
  v_mfma_f32_32x32x16_bf16 v[128:143], v[80:83], v[40:43], v[128:143]
  s_add_u32 s45, s44, 16384
  buffer_load_dwordx4 v[32:35], v2, s[24:27], s45 offen offset:0 sc1
  v_mfma_f32_32x32x16_bf16 v[144:159], v[84:87], v[40:43], v[144:159]
  s_waitcnt vmcnt(9)
  v_mfma_f32_32x32x16_bf16 v[128:143], v[88:91], v[44:47], v[128:143]
  buffer_load_dwordx4 v[36:39], v2, s[24:27], s45 offen offset:1024 sc1
  v_mfma_f32_32x32x16_bf16 v[144:159], v[92:95], v[44:47], v[144:159]
  s_waitcnt vmcnt(9)
  v_mfma_f32_32x32x16_bf16 v[128:143], v[96:99], v[48:51], v[128:143]
  buffer_load_dwordx4 v[40:43], v2, s[24:27], s45 offen offset:2048 sc1
  v_mfma_f32_32x32x16_bf16 v[144:159], v[100:103], v[48:51], v[144:159]
  s_waitcnt vmcnt(9)
  v_mfma_f32_32x32x16_bf16 v[128:143], v[104:107], v[52:55], v[128:143]
  buffer_load_dwordx4 v[44:47], v2, s[24:27], s45 offen offset:3072 sc1
  v_mfma_f32_32x32x16_bf16 v[144:159], v[108:111], v[52:55], v[144:159]
  s_waitcnt vmcnt(9)
  v_mfma_f32_32x32x16_bf16 v[128:143], v[112:115], v[56:59], v[128:143]
  s_add_u32 s45, s44, 20480
  buffer_load_dwordx4 v[48:51], v2, s[24:27], s45 offen offset:0 sc1
  v_mfma_f32_32x32x16_bf16 v[144:159], v[116:119], v[56:59], v[144:159]
  s_waitcnt vmcnt(9)
  v_mfma_f32_32x32x16_bf16 v[128:143], v[120:123], v[60:63], v[128:143]
  buffer_load_dwordx4 v[52:55], v2, s[24:27], s45 offen offset:1024 sc1
  v_mfma_f32_32x32x16_bf16 v[144:159], v[124:127], v[60:63], v[144:159]
  s_waitcnt vmcnt(9)
  v_mfma_f32_32x32x16_bf16 v[128:143], a[0:3], v[16:19], v[128:143]
  buffer_load_dwordx4 v[56:59], v2, s[24:27], s45 offen offset:2048 sc1
  v_mfma_f32_32x32x16_bf16 v[144:159], a[8:11], v[16:19], v[144:159]
  s_waitcnt vmcnt(9)
  v_mfma_f32_32x32x16_bf16 v[128:143], a[16:19], v[20:23], v[128:143]
  buffer_load_dwordx4 v[60:63], v2, s[24:27], s45 offen offset:3072 sc1
  v_mfma_f32_32x32x16_bf16 v[144:159], a[24:27], v[20:23], v[144:159]
  buffer_load_dword v13, v1, s[24:27], s39 offen sc1
  s_waitcnt vmcnt(10)
  v_mfma_f32_32x32x16_bf16 v[128:143], a[32:35], v[24:27], v[128:143]
  s_add_u32 s45, s44, 24576
  buffer_load_dwordx4 v[16:19], v2, s[24:27], s45 offen offset:0 sc1
  v_mfma_f32_32x32x16_bf16 v[144:159], a[40:43], v[24:27], v[144:159]
  s_waitcnt vmcnt(10)
  v_mfma_f32_32x32x16_bf16 v[128:143], a[48:51], v[28:31], v[128:143]
  buffer_load_dwordx4 v[20:23], v2, s[24:27], s45 offen offset:1024 sc1
  v_mfma_f32_32x32x16_bf16 v[144:159], a[56:59], v[28:31], v[144:159]
  s_waitcnt vmcnt(10)
  v_mfma_f32_32x32x16_bf16 v[128:143], a[64:67], v[32:35], v[128:143]
  buffer_load_dwordx4 v[24:27], v2, s[24:27], s45 offen offset:2048 sc1
  v_mfma_f32_32x32x16_bf16 v[144:159], a[72:75], v[32:35], v[144:159]
  s_waitcnt vmcnt(10)
  v_mfma_f32_32x32x16_bf16 v[128:143], a[80:83], v[36:39], v[128:143]
  buffer_load_dwordx4 v[28:31], v2, s[24:27], s45 offen offset:3072 sc1
  v_mfma_f32_32x32x16_bf16 v[144:159], a[88:91], v[36:39], v[144:159]
  s_waitcnt vmcnt(4)
  s_mov_b32 s5, 0x8000
  s_branch pollBc
pollB:
  buffer_load_dword v13, v1, s[24:27], s39 offen offset:0 sc1
  s_waitcnt vmcnt(0)
pollBc:
  v_readfirstlane_b32 s6, v13
  s_sub_u32 s5, s5, 1
  s_cbranch_scc1 pollBd
  s_cmp_lt_u32 s6, 14
  s_cbranch_scc1 pollB
pollBd:
  v_mfma_f32_32x32x16_bf16 v[128:143], a[96:99], v[40:43], v[128:143]
  s_add_u32 s45, s44, 229376
  buffer_load_dwordx4 v[32:35], v2, s[24:27], s45 offen offset:0 sc1
  v_mfma_f32_32x32x16_bf16 v[144:159], a[104:107], v[40:43], v[144:159]
  v_mfma_f32_32x32x16_bf16 v[128:143], a[112:115], v[44:47], v[128:143]
  buffer_load_dwordx4 v[36:39], v2, s[24:27], s45 offen offset:1024 sc1
  v_mfma_f32_32x32x16_bf16 v[144:159], a[120:123], v[44:47], v[144:159]
  v_mfma_f32_32x32x16_bf16 v[128:143], a[128:131], v[48:51], v[128:143]
  buffer_load_dwordx4 v[40:43], v2, s[24:27], s45 offen offset:2048 sc1
  v_mfma_f32_32x32x16_bf16 v[144:159], a[136:139], v[48:51], v[144:159]
  v_mfma_f32_32x32x16_bf16 v[128:143], a[144:147], v[52:55], v[128:143]
  buffer_load_dwordx4 v[44:47], v2, s[24:27], s45 offen offset:3072 sc1
  v_mfma_f32_32x32x16_bf16 v[144:159], a[152:155], v[52:55], v[144:159]
  v_mfma_f32_32x32x16_bf16 v[128:143], a[160:163], v[56:59], v[128:143]
  s_add_u32 s45, s44, 233472
  buffer_load_dwordx4 v[48:51], v2, s[24:27], s45 offen offset:0 sc1
  v_mfma_f32_32x32x16_bf16 v[144:159], a[168:171], v[56:59], v[144:159]
  v_mfma_f32_32x32x16_bf16 v[128:143], a[176:179], v[60:63], v[128:143]
  buffer_load_dwordx4 v[52:55], v2, s[24:27], s45 offen offset:1024 sc1
  v_mfma_f32_32x32x16_bf16 v[144:159], a[184:187], v[60:63], v[144:159]
  s_waitcnt vmcnt(9)
  v_mfma_f32_32x32x16_bf16 v[128:143], a[192:195], v[16:19], v[128:143]
  buffer_load_dwordx4 v[56:59], v2, s[24:27], s45 offen offset:2048 sc1
  v_mfma_f32_32x32x16_bf16 v[144:159], a[200:203], v[16:19], v[144:159]
  s_waitcnt vmcnt(9)
  v_mfma_f32_32x32x16_bf16 v[128:143], a[208:211], v[20:23], v[128:143]
  buffer_load_dwordx4 v[60:63], v2, s[24:27], s45 offen offset:3072 sc1
  v_mfma_f32_32x32x16_bf16 v[144:159], a[216:219], v[20:23], v[144:159]
  s_waitcnt vmcnt(9)
  v_mfma_f32_32x32x16_bf16 v[128:143], a[4:7], v[24:27], v[128:143]
  s_add_u32 s45, s44, 237568
  buffer_load_dwordx4 v[16:19], v2, s[24:27], s45 offen offset:0 sc1
  v_mfma_f32_32x32x16_bf16 v[144:159], a[12:15], v[24:27], v[144:159]
  s_waitcnt vmcnt(9)
  v_mfma_f32_32x32x16_bf16 v[128:143], a[20:23], v[28:31], v[128:143]
  buffer_load_dwordx4 v[20:23], v2, s[24:27], s45 offen offset:1024 sc1
  v_mfma_f32_32x32x16_bf16 v[144:159], a[28:31], v[28:31], v[144:159]
  s_waitcnt vmcnt(9)
  v_mfma_f32_32x32x16_bf16 v[160:175], a[224:227], v[32:35], 0
  buffer_load_dwordx4 v[24:27], v2, s[24:27], s45 offen offset:2048 sc1
  v_mfma_f32_32x32x16_bf16 v[176:191], a[228:231], v[32:35], 0
  s_waitcnt vmcnt(9)
  v_mfma_f32_32x32x16_bf16 v[160:175], a[232:235], v[36:39], v[160:175]
  buffer_load_dwordx4 v[28:31], v2, s[24:27], s45 offen offset:3072 sc1
  v_mfma_f32_32x32x16_bf16 v[176:191], a[236:239], v[36:39], v[176:191]
  s_waitcnt vmcnt(9)
  v_mfma_f32_32x32x16_bf16 v[160:175], a[240:243], v[40:43], v[160:175]
  s_add_u32 s45, s44, 241664
  buffer_load_dwordx4 v[32:35], v2, s[24:27], s45 offen offset:0 sc1
  v_mfma_f32_32x32x16_bf16 v[176:191], a[244:247], v[40:43], v[176:191]
  s_waitcnt vmcnt(9)
  v_mfma_f32_32x32x16_bf16 v[160:175], a[248:251], v[44:47], v[160:175]
  buffer_load_dwordx4 v[36:39], v2, s[24:27], s45 offen offset:1024 sc1
  v_mfma_f32_32x32x16_bf16 v[176:191], a[252:255], v[44:47], v[176:191]
  s_waitcnt vmcnt(9)
  v_mfma_f32_32x32x16_bf16 v[160:175], v[64:67], v[48:51], v[160:175]
  buffer_load_dwordx4 v[40:43], v2, s[24:27], s45 offen offset:2048 sc1
  v_mfma_f32_32x32x16_bf16 v[176:191], v[68:71], v[48:51], v[176:191]
  ds_write_b128 v9, v[128:131] offset:0
  s_waitcnt vmcnt(9)
  v_mfma_f32_32x32x16_bf16 v[160:175], v[72:75], v[52:55], v[160:175]
  buffer_load_dwordx4 v[44:47], v2, s[24:27], s45 offen offset:3072 sc1
  v_mfma_f32_32x32x16_bf16 v[176:191], v[76:79], v[52:55], v[176:191]
  s_waitcnt vmcnt(9)
  v_mfma_f32_32x32x16_bf16 v[160:175], v[80:83], v[56:59], v[160:175]
  s_add_u32 s45, s44, 245760
  buffer_load_dwordx4 v[48:51], v2, s[24:27], s45 offen offset:0 sc1
  v_mfma_f32_32x32x16_bf16 v[176:191], v[84:87], v[56:59], v[176:191]
  ds_write_b128 v9, v[132:135] offset:1024
  s_waitcnt vmcnt(9)
  v_mfma_f32_32x32x16_bf16 v[160:175], v[88:91], v[60:63], v[160:175]
  buffer_load_dwordx4 v[52:55], v2, s[24:27], s45 offen offset:1024 sc1
  v_mfma_f32_32x32x16_bf16 v[176:191], v[92:95], v[60:63], v[176:191]
  s_waitcnt vmcnt(9)
  v_mfma_f32_32x32x16_bf16 v[160:175], v[96:99], v[16:19], v[160:175]
  buffer_load_dwordx4 v[56:59], v2, s[24:27], s45 offen offset:2048 sc1
  v_mfma_f32_32x32x16_bf16 v[176:191], v[100:103], v[16:19], v[176:191]
  ds_write_b128 v9, v[136:139] offset:2048
  s_waitcnt vmcnt(9)
  v_mfma_f32_32x32x16_bf16 v[160:175], v[104:107], v[20:23], v[160:175]
  buffer_load_dwordx4 v[60:63], v2, s[24:27], s45 offen offset:3072 sc1
  v_mfma_f32_32x32x16_bf16 v[176:191], v[108:111], v[20:23], v[176:191]
  s_waitcnt vmcnt(9)
  v_mfma_f32_32x32x16_bf16 v[160:175], v[112:115], v[24:27], v[160:175]
  s_add_u32 s45, s44, 249856
  buffer_load_dwordx4 v[16:19], v2, s[24:27], s45 offen offset:0 sc1
  v_mfma_f32_32x32x16_bf16 v[176:191], v[116:119], v[24:27], v[176:191]
  ds_write_b128 v9, v[140:143] offset:3072
  s_waitcnt vmcnt(9)
  v_mfma_f32_32x32x16_bf16 v[160:175], v[120:123], v[28:31], v[160:175]
  buffer_load_dwordx4 v[20:23], v2, s[24:27], s45 offen offset:1024 sc1
  v_mfma_f32_32x32x16_bf16 v[176:191], v[124:127], v[28:31], v[176:191]
  s_waitcnt vmcnt(9)
  v_mfma_f32_32x32x16_bf16 v[160:175], a[0:3], v[32:35], v[160:175]
  buffer_load_dwordx4 v[24:27], v2, s[24:27], s45 offen offset:2048 sc1
  v_mfma_f32_32x32x16_bf16 v[176:191], a[8:11], v[32:35], v[176:191]
  ds_write_b128 v10, v[144:147] offset:0
  s_waitcnt vmcnt(9)
  v_mfma_f32_32x32x16_bf16 v[160:175], a[16:19], v[36:39], v[160:175]
  buffer_load_dwordx4 v[28:31], v2, s[24:27], s45 offen offset:3072 sc1
  v_mfma_f32_32x32x16_bf16 v[176:191], a[24:27], v[36:39], v[176:191]
  s_waitcnt vmcnt(9)
  v_mfma_f32_32x32x16_bf16 v[160:175], a[32:35], v[40:43], v[160:175]
  s_add_u32 s45, s44, 253952
  buffer_load_dwordx4 v[32:35], v2, s[24:27], s45 offen offset:0 sc1
  v_mfma_f32_32x32x16_bf16 v[176:191], a[40:43], v[40:43], v[176:191]
  ds_write_b128 v10, v[148:151] offset:1024
  s_waitcnt vmcnt(9)
  v_mfma_f32_32x32x16_bf16 v[160:175], a[48:51], v[44:47], v[160:175]
  buffer_load_dwordx4 v[36:39], v2, s[24:27], s45 offen offset:1024 sc1
  v_mfma_f32_32x32x16_bf16 v[176:191], a[56:59], v[44:47], v[176:191]
  s_waitcnt vmcnt(9)
  v_mfma_f32_32x32x16_bf16 v[160:175], a[64:67], v[48:51], v[160:175]
  buffer_load_dwordx4 v[40:43], v2, s[24:27], s45 offen offset:2048 sc1
  v_mfma_f32_32x32x16_bf16 v[176:191], a[72:75], v[48:51], v[176:191]
  ds_write_b128 v10, v[152:155] offset:2048
  s_waitcnt vmcnt(9)
  v_mfma_f32_32x32x16_bf16 v[160:175], a[80:83], v[52:55], v[160:175]
  buffer_load_dwordx4 v[44:47], v2, s[24:27], s45 offen offset:3072 sc1
  v_mfma_f32_32x32x16_bf16 v[176:191], a[88:91], v[52:55], v[176:191]
  s_waitcnt vmcnt(9)
  v_mfma_f32_32x32x16_bf16 v[160:175], a[96:99], v[56:59], v[160:175]
  ds_write_b128 v10, v[156:159] offset:3072
  v_mfma_f32_32x32x16_bf16 v[176:191], a[104:107], v[56:59], v[176:191]
  s_waitcnt vmcnt(8)
  v_mfma_f32_32x32x16_bf16 v[160:175], a[112:115], v[60:63], v[160:175]
  v_mfma_f32_32x32x16_bf16 v[176:191], a[120:123], v[60:63], v[176:191]
  s_waitcnt vmcnt(7)
  v_mfma_f32_32x32x16_bf16 v[160:175], a[128:131], v[16:19], v[160:175]
  v_mfma_f32_32x32x16_bf16 v[176:191], a[136:139], v[16:19], v[176:191]
  s_waitcnt vmcnt(6)
  v_mfma_f32_32x32x16_bf16 v[160:175], a[144:147], v[20:23], v[160:175]
  v_mfma_f32_32x32x16_bf16 v[176:191], a[152:155], v[20:23], v[176:191]
  s_waitcnt vmcnt(5)
  v_mfma_f32_32x32x16_bf16 v[160:175], a[160:163], v[24:27], v[160:175]
  v_mfma_f32_32x32x16_bf16 v[176:191], a[168:171], v[24:27], v[176:191]
  s_waitcnt vmcnt(4)
  v_mfma_f32_32x32x16_bf16 v[160:175], a[176:179], v[28:31], v[160:175]
  v_mfma_f32_32x32x16_bf16 v[176:191], a[184:187], v[28:31], v[176:191]
  s_waitcnt vmcnt(3)
  v_mfma_f32_32x32x16_bf16 v[160:175], a[192:195], v[32:35], v[160:175]
  v_mfma_f32_32x32x16_bf16 v[176:191], a[200:203], v[32:35], v[176:191]
  s_waitcnt vmcnt(2)
  v_mfma_f32_32x32x16_bf16 v[160:175], a[208:211], v[36:39], v[160:175]
  v_mfma_f32_32x32x16_bf16 v[176:191], a[216:219], v[36:39], v[176:191]
  s_waitcnt vmcnt(1)
  v_mfma_f32_32x32x16_bf16 v[160:175], a[4:7], v[40:43], v[160:175]
  v_mfma_f32_32x32x16_bf16 v[176:191], a[12:15], v[40:43], v[176:191]
  s_waitcnt vmcnt(0)
  v_mfma_f32_32x32x16_bf16 v[160:175], a[20:23], v[44:47], v[160:175]
  v_mfma_f32_32x32x16_bf16 v[176:191], a[28:31], v[44:47], v[176:191]
  v_lshlrev_b32 v16, 16, v248
  v_and_b32 v17, 0xffff0000, v248
  v_lshlrev_b32 v18, 16, v249
  v_and_b32 v19, 0xffff0000, v249
  v_lshlrev_b32 v20, 16, v250
  v_and_b32 v21, 0xffff0000, v250
  v_lshlrev_b32 v22, 16, v251
  v_and_b32 v23, 0xffff0000, v251
  v_lshlrev_b32 v24, 16, v252
  v_and_b32 v25, 0xffff0000, v252
  v_lshlrev_b32 v26, 16, v253
  v_and_b32 v27, 0xffff0000, v253
  v_lshlrev_b32 v28, 16, v254
  v_and_b32 v29, 0xffff0000, v254
  v_lshlrev_b32 v30, 16, v255
  v_and_b32 v31, 0xffff0000, v255
  ds_write_b128 v9, v[160:163] offset:16384
  ds_write_b128 v9, v[164:167] offset:17408
  ds_write_b128 v9, v[168:171] offset:18432
  ds_write_b128 v9, v[172:175] offset:19456
  ds_write_b128 v10, v[176:179] offset:16384
  ds_write_b128 v10, v[180:183] offset:17408
  ds_write_b128 v10, v[184:187] offset:18432
  ds_write_b128 v10, v[188:191] offset:19456
  s_waitcnt lgkmcnt(0)
  s_barrier
  ds_read_b128 v[64:67], v12 offset:0
  ds_read_b128 v[68:71], v12 offset:1024
  ds_read_b128 v[72:75], v12 offset:2048
  ds_read_b128 v[76:79], v12 offset:3072
  ds_read_b128 v[80:83], v12 offset:4096
  ds_read_b128 v[84:87], v12 offset:5120
  ds_read_b128 v[88:91], v12 offset:6144
  ds_read_b128 v[92:95], v12 offset:7168
  ds_read_b128 v[96:99], v12 offset:8192
  ds_read_b128 v[100:103], v12 offset:9216
  ds_read_b128 v[104:107], v12 offset:10240
  ds_read_b128 v[108:111], v12 offset:11264
  ds_read_b128 v[112:115], v12 offset:12288
  ds_read_b128 v[116:119], v12 offset:13312
  ds_read_b128 v[120:123], v12 offset:14336
  ds_read_b128 v[124:127], v12 offset:15360
  s_waitcnt lgkmcnt(12)
  v_add_f32 v16, v16, v64
  v_add_f32 v17, v17, v65
  v_add_f32 v18, v18, v66
  v_add_f32 v19, v19, v67
  v_add_f32 v20, v20, v68
  v_add_f32 v21, v21, v69
  v_add_f32 v22, v22, v70
  v_add_f32 v23, v23, v71
  v_add_f32 v24, v24, v72
  v_add_f32 v25, v25, v73
  v_add_f32 v26, v26, v74
  v_add_f32 v27, v27, v75
  v_add_f32 v28, v28, v76
  v_add_f32 v29, v29, v77
  v_add_f32 v30, v30, v78
  v_add_f32 v31, v31, v79
  s_waitcnt lgkmcnt(8)
  v_add_f32 v16, v16, v80
  v_add_f32 v17, v17, v81
  v_add_f32 v18, v18, v82
  v_add_f32 v19, v19, v83
  v_add_f32 v20, v20, v84
  v_add_f32 v21, v21, v85
  v_add_f32 v22, v22, v86
  v_add_f32 v23, v23, v87
  v_add_f32 v24, v24, v88
  v_add_f32 v25, v25, v89
  v_add_f32 v26, v26, v90
  v_add_f32 v27, v27, v91
  v_add_f32 v28, v28, v92
  v_add_f32 v29, v29, v93
  v_add_f32 v30, v30, v94
  v_add_f32 v31, v31, v95
  s_waitcnt lgkmcnt(4)
  v_add_f32 v16, v16, v96
  v_add_f32 v17, v17, v97
  v_add_f32 v18, v18, v98
  v_add_f32 v19, v19, v99
  v_add_f32 v20, v20, v100
  v_add_f32 v21, v21, v101
  v_add_f32 v22, v22, v102
  v_add_f32 v23, v23, v103
  v_add_f32 v24, v24, v104
  v_add_f32 v25, v25, v105
  v_add_f32 v26, v26, v106
  v_add_f32 v27, v27, v107
  v_add_f32 v28, v28, v108
  v_add_f32 v29, v29, v109
  v_add_f32 v30, v30, v110
  v_add_f32 v31, v31, v111
  s_waitcnt lgkmcnt(0)
  v_add_f32 v16, v16, v112
  v_add_f32 v17, v17, v113
  v_add_f32 v18, v18, v114
  v_add_f32 v19, v19, v115
  v_add_f32 v20, v20, v116
  v_add_f32 v21, v21, v117
  v_add_f32 v22, v22, v118
  v_add_f32 v23, v23, v119
  v_add_f32 v24, v24, v120
  v_add_f32 v25, v25, v121
  v_add_f32 v26, v26, v122
  v_add_f32 v27, v27, v123
  v_add_f32 v28, v28, v124
  v_add_f32 v29, v29, v125
  v_add_f32 v30, v30, v126
  v_add_f32 v31, v31, v127
  v_cvt_pk_bf16_f32 v248, v16, v17
  v_cvt_pk_bf16_f32 v249, v18, v19
  v_cvt_pk_bf16_f32 v250, v20, v21
  v_cvt_pk_bf16_f32 v251, v22, v23
  v_cvt_pk_bf16_f32 v252, v24, v25
  v_cvt_pk_bf16_f32 v253, v26, v27
  v_cvt_pk_bf16_f32 v254, v28, v29
  v_cvt_pk_bf16_f32 v255, v30, v31
  s_cmp_eq_u32 s56, 1
  s_cbranch_scc1 final
  s_add_u32 s4, s49, 4194304
  buffer_store_dwordx4 v[248:251], v2, s[24:27], s4 offen sc1
  buffer_store_dwordx4 v[252:255], v2, s[24:27], s4 offen offset:1024 sc1
  v_add_f32 v32, v16, v17
  v_add_f32 v33, v18, v19
  v_mul_f32 v34, v16, v16
  v_mul_f32 v35, v17, v17
  v_fmac_f32 v34, v18, v18
  v_fmac_f32 v35, v19, v19
  v_add_f32 v32, v32, v20
  v_add_f32 v33, v33, v21
  v_fmac_f32 v34, v20, v20
  v_fmac_f32 v35, v21, v21
  v_add_f32 v32, v32, v22
  v_add_f32 v33, v33, v23
  v_fmac_f32 v34, v22, v22
  v_fmac_f32 v35, v23, v23
  v_add_f32 v32, v32, v24
  v_add_f32 v33, v33, v25
  v_fmac_f32 v34, v24, v24
  v_fmac_f32 v35, v25, v25
  v_add_f32 v32, v32, v26
  v_add_f32 v33, v33, v27
  v_fmac_f32 v34, v26, v26
  v_fmac_f32 v35, v27, v27
  v_add_f32 v32, v32, v28
  v_add_f32 v33, v33, v29
  v_fmac_f32 v34, v28, v28
  v_fmac_f32 v35, v29, v29
  v_add_f32 v32, v32, v30
  v_add_f32 v33, v33, v31
  v_fmac_f32 v34, v30, v30
  v_fmac_f32 v35, v31, v31
  v_add_f32 v32, v32, v33
  v_add_f32 v34, v34, v35
  s_lshl_b32 s4, s12, 12
  s_lshl_b32 s5, s14, 8
  v_permlane32_swap_b32 v32, v34
  s_add_u32 s4, s4, s5
  s_add_u32 s4, s4, 35127296
  s_nop 0
  v_add_f32 v32, v32, v34
  buffer_store_dword v32, v3, s[24:27], s4 offen sc1
  s_waitcnt vmcnt(0) lgkmcnt(0)
  s_barrier
  s_cmp_eq_u32 s20, 0
  s_cbranch_scc0 sig9
  s_lshl_b32 s4, s21, 8
  s_add_u32 s4, s4, s59
  s_add_u32 s4, s4, 16384
  s_mov_b64 exec, 1
  v_mov_b32 v4, 1
  buffer_atomic_add v4, v1, s[24:27], s4 offen sc1
  s_mov_b64 exec, -1
sig9:
  s_add_u32 m0, s42, 0
  s_add_u32 s45, s43, 0
  buffer_load_dwordx4 v2, s[24:27], s45 offen offset:0 sc1 lds
  buffer_load_dwordx4 v2, s[24:27], s45 offen offset:1024 sc1 lds
  buffer_load_dwordx4 v2, s[24:27], s45 offen offset:2048 sc1 lds
  s_add_u32 m0, s42, 12288
  s_add_u32 s45, s43, 12288
  buffer_load_dwordx4 v2, s[24:27], s45 offen offset:0 sc1 lds
  buffer_load_dwordx4 v2, s[24:27], s45 offen offset:1024 sc1 lds
  buffer_load_dwordx4 v2, s[24:27], s45 offen offset:2048 sc1 lds
  s_add_u32 m0, s42, 24576
  s_add_u32 s45, s43, 24576
  buffer_load_dwordx4 v2, s[24:27], s45 offen offset:0 sc1 lds
  buffer_load_dwordx4 v2, s[24:27], s45 offen offset:1024 sc1 lds
  buffer_load_dwordx4 v2, s[24:27], s45 offen offset:2048 sc1 lds
  s_add_u32 m0, s42, 36864
  s_add_u32 s45, s43, 36864
  buffer_load_dwordx4 v2, s[24:27], s45 offen offset:0 sc1 lds
  buffer_load_dwordx4 v2, s[24:27], s45 offen offset:1024 sc1 lds
  buffer_load_dwordx4 v2, s[24:27], s45 offen offset:2048 sc1 lds
  s_add_u32 m0, s42, 49152
  s_add_u32 s45, s43, 49152
  buffer_load_dwordx4 v2, s[24:27], s45 offen offset:0 sc1 lds
  buffer_load_dwordx4 v2, s[24:27], s45 offen offset:1024 sc1 lds
  buffer_load_dwordx4 v2, s[24:27], s45 offen offset:2048 sc1 lds
  s_add_u32 m0, s42, 61440
  s_add_u32 s45, s43, 61440
  buffer_load_dwordx4 v2, s[24:27], s45 offen offset:0 sc1 lds
  buffer_load_dwordx4 v2, s[24:27], s45 offen offset:1024 sc1 lds
  buffer_load_dwordx4 v2, s[24:27], s45 offen offset:2048 sc1 lds
  s_add_u32 m0, s42, 73728
  s_add_u32 s45, s43, 73728
  buffer_load_dwordx4 v2, s[24:27], s45 offen offset:0 sc1 lds
  buffer_load_dwordx4 v2, s[24:27], s45 offen offset:1024 sc1 lds
  buffer_load_dwordx4 v2, s[24:27], s45 offen offset:2048 sc1 lds
next:
  s_mov_b32 s56, 1
  s_add_u32 s59, s59, 20480
  s_mov_b32 s58, 35651584
  s_mov_b32 s60, 18874368
  s_mov_b32 s61, 40894464
  s_cmp_eq_u32 s20, 0
  s_cbranch_scc0 wt10d
  s_lshl_b32 s4, s21, 8
  s_add_u32 s4, s4, s59
  s_add_u32 s4, s4, -4096
  s_mov_b32 s5, 0x8000
wt10:
  buffer_load_dword v4, v1, s[24:27], s4 offen sc1
  s_sub_u32 s5, s5, 1
  s_cbranch_scc1 wt10d
  s_waitcnt vmcnt(0)
  v_readfirstlane_b32 s6, v4
  s_cmp_lt_u32 s6, 14
  s_cbranch_scc1 wt10
wt10d:
  s_waitcnt lgkmcnt(0)
  s_barrier
  s_branch layer
idle:
  s_cmp_eq_u32 s56, 0
  s_cbranch_scc1 next
  s_endpgm
final:
  s_mov_b32 s32, s16
  s_and_b32 s33, s17, 0xffff
  s_mov_b32 s34, 1835008
  s_mov_b32 s35, 0x20000
  v_and_b32 v9, 31, v0
  v_bfe_u32 v4, v0, 5, 1
  v_mul_u32_u24 v9, 896, v9
  v_lshl_add_u32 v9, v4, 4, v9
  s_mul_i32 s4, s12, 28672
  s_lshl_b32 s5, s14, 6
  s_add_u32 s4, s4, s5
  v_permlane32_swap_b32 v248, v250
  v_permlane32_swap_b32 v249, v251
  v_permlane32_swap_b32 v252, v254
  v_permlane32_swap_b32 v253, v255
  s_nop 1
  buffer_store_dwordx4 v[248:251], v9, s[32:35], s4 offen
  buffer_store_dwordx4 v[252:255], v9, s[32:35], s4 offen offset:32
  s_endpgm
attn_fb:
  s_mov_b32 s52, 1
  s_mov_b32 s45, s44
  s_mov_b32 s4, 16
  v_mov_b32 v220, 0xff800000
  v_cndmask_b32 v18, v18, v1, s[28:29]
  v_mov_b32 v221, 0xff800000
  v_cndmask_b32 v26, v26, v1, s[28:29]
  v_mov_b32 v222, 0xff800000
  v_cndmask_b32 v34, v34, v1, s[28:29]
  v_mov_b32 v223, 0xff800000
  v_cndmask_b32 v42, v42, v1, s[28:29]
attn_fbl:
  buffer_load_dwordx4 v[156:159], v2, s[24:27], s45 offen sc1
  buffer_load_dwordx4 v[160:163], v2, s[24:27], s45 offen offset:1024 sc1
  s_add_u32 s45, s45, 4096
  s_waitcnt vmcnt(0)
  v_mfma_f32_32x32x16_bf16 v[44:59], v[156:159], v[12:15], 0
  v_mfma_f32_32x32x16_bf16 v[44:59], v[160:163], v[16:19], v[44:59]
  v_mfma_f32_32x32x16_bf16 v[60:75], v[156:159], v[20:23], 0
  v_mfma_f32_32x32x16_bf16 v[60:75], v[160:163], v[24:27], v[60:75]
  v_mfma_f32_32x32x16_bf16 v[76:91], v[156:159], v[28:31], 0
  v_mfma_f32_32x32x16_bf16 v[76:91], v[160:163], v[32:35], v[76:91]
  v_mfma_f32_32x32x16_bf16 v[92:107], v[156:159], v[36:39], 0
  v_mfma_f32_32x32x16_bf16 v[92:107], v[160:163], v[40:43], v[92:107]
  s_nop 15
  v_max3_f32 v220, v220, v44, v45
  v_max3_f32 v220, v220, v46, v47
  v_max3_f32 v220, v220, v48, v49
  v_max3_f32 v220, v220, v50, v51
  v_max3_f32 v220, v220, v52, v53
  v_max3_f32 v220, v220, v54, v55
  v_max3_f32 v220, v220, v56, v57
  v_max3_f32 v220, v220, v58, v59
  v_max3_f32 v221, v221, v60, v61
  v_max3_f32 v221, v221, v62, v63
  v_max3_f32 v221, v221, v64, v65
  v_max3_f32 v221, v221, v66, v67
  v_max3_f32 v221, v221, v68, v69
  v_max3_f32 v221, v221, v70, v71
  v_max3_f32 v221, v221, v72, v73
  v_max3_f32 v221, v221, v74, v75
  v_max3_f32 v222, v222, v76, v77
  v_max3_f32 v222, v222, v78, v79
  v_max3_f32 v222, v222, v80, v81
  v_max3_f32 v222, v222, v82, v83
  v_max3_f32 v222, v222, v84, v85
  v_max3_f32 v222, v222, v86, v87
  v_max3_f32 v222, v222, v88, v89
  v_max3_f32 v222, v222, v90, v91
  v_max3_f32 v223, v223, v92, v93
  v_max3_f32 v223, v223, v94, v95
  v_max3_f32 v223, v223, v96, v97
  v_max3_f32 v223, v223, v98, v99
  v_max3_f32 v223, v223, v100, v101
  v_max3_f32 v223, v223, v102, v103
  v_max3_f32 v223, v223, v104, v105
  v_max3_f32 v223, v223, v106, v107
  s_sub_u32 s4, s4, 1
  s_cmp_lg_u32 s4, 0
  s_cbranch_scc1 attn_fbl
  v_and_b32 v4, 31, v0
  v_lshlrev_b32 v4, 2, v4
  v_mov_b32 v224, v220
  s_xor_b32 s4, s20, 0
  s_lshl_b32 s4, s4, 9
  v_permlane32_swap_b32 v220, v224
  s_add_u32 s4, s4, 95488
  v_add_u32 v228, s4, v4
  s_lshl_b32 s5, s20, 7
  v_max_f32 v220, v220, v224
  v_add_u32 v225, s5, v228
  ds_write_b32 v225, v220
  v_mov_b32 v224, v221
  s_xor_b32 s4, s20, 1
  s_lshl_b32 s4, s4, 9
  v_permlane32_swap_b32 v221, v224
  s_add_u32 s4, s4, 95488
  v_add_u32 v229, s4, v4
  s_lshl_b32 s5, s20, 7
  v_max_f32 v221, v221, v224
  v_add_u32 v225, s5, v229
  ds_write_b32 v225, v221
  v_mov_b32 v224, v222
  s_xor_b32 s4, s20, 2
  s_lshl_b32 s4, s4, 9
  v_permlane32_swap_b32 v222, v224
  s_add_u32 s4, s4, 95488
  v_add_u32 v230, s4, v4
  s_lshl_b32 s5, s20, 7
  v_max_f32 v222, v222, v224
  v_add_u32 v225, s5, v230
  ds_write_b32 v225, v222
  v_mov_b32 v224, v223
  s_xor_b32 s4, s20, 3
  s_lshl_b32 s4, s4, 9
  v_permlane32_swap_b32 v223, v224
  s_add_u32 s4, s4, 95488
  v_add_u32 v231, s4, v4
  s_lshl_b32 s5, s20, 7
  v_max_f32 v223, v223, v224
  v_add_u32 v225, s5, v231
  ds_write_b32 v225, v223
  s_waitcnt lgkmcnt(0)
  s_barrier
  ds_read_b32 v44, v228 offset:0
  ds_read_b32 v45, v228 offset:128
  ds_read_b32 v46, v228 offset:256
  ds_read_b32 v47, v228 offset:384
  ds_read_b32 v48, v229 offset:0
  ds_read_b32 v49, v229 offset:128
  ds_read_b32 v50, v229 offset:256
  ds_read_b32 v51, v229 offset:384
  ds_read_b32 v52, v230 offset:0
  ds_read_b32 v53, v230 offset:128
  ds_read_b32 v54, v230 offset:256
  ds_read_b32 v55, v230 offset:384
  ds_read_b32 v56, v231 offset:0
  ds_read_b32 v57, v231 offset:128
  ds_read_b32 v58, v231 offset:256
  ds_read_b32 v59, v231 offset:384
  s_waitcnt lgkmcnt(0)
  v_max3_f32 v44, v44, v45, v46
  v_max_f32 v44, v44, v47
  v_cvt_pk_bf16_f32 v45, -v44, 0
  v_lshlrev_b32 v46, 16, v45
  v_sub_f32 v44, -v44, v46
  v_cvt_pk_bf16_f32 v46, v44, 0
  v_lshlrev_b32 v46, 16, v46
  v_sub_f32 v44, v44, v46
  v_or_b32 v45, v45, v46
  v_cvt_pk_bf16_f32 v44, v44, 0
  v_cndmask_b32 v18, v18, v45, s[28:29]
  v_cndmask_b32 v19, v19, v44, s[28:29]
  v_max3_f32 v48, v48, v49, v50
  v_max_f32 v48, v48, v51
  v_cvt_pk_bf16_f32 v49, -v48, 0
  v_lshlrev_b32 v50, 16, v49
  v_sub_f32 v48, -v48, v50
  v_cvt_pk_bf16_f32 v50, v48, 0
  v_lshlrev_b32 v50, 16, v50
  v_sub_f32 v48, v48, v50
  v_or_b32 v49, v49, v50
  v_cvt_pk_bf16_f32 v48, v48, 0
  v_cndmask_b32 v26, v26, v49, s[28:29]
  v_cndmask_b32 v27, v27, v48, s[28:29]
  v_max3_f32 v52, v52, v53, v54
  v_max_f32 v52, v52, v55
  v_cvt_pk_bf16_f32 v53, -v52, 0
  v_lshlrev_b32 v54, 16, v53
  v_sub_f32 v52, -v52, v54
  v_cvt_pk_bf16_f32 v54, v52, 0
  v_lshlrev_b32 v54, 16, v54
  v_sub_f32 v52, v52, v54
  v_or_b32 v53, v53, v54
  v_cvt_pk_bf16_f32 v52, v52, 0
  v_cndmask_b32 v34, v34, v53, s[28:29]
  v_cndmask_b32 v35, v35, v52, s[28:29]
  v_max3_f32 v56, v56, v57, v58
  v_max_f32 v56, v56, v59
  v_cvt_pk_bf16_f32 v57, -v56, 0
  v_lshlrev_b32 v58, 16, v57
  v_sub_f32 v56, -v56, v58
  v_cvt_pk_bf16_f32 v58, v56, 0
  v_lshlrev_b32 v58, 16, v58
  v_sub_f32 v56, v56, v58
  v_or_b32 v57, v57, v58
  v_cvt_pk_bf16_f32 v56, v56, 0
  v_cndmask_b32 v42, v42, v57, s[28:29]
  v_cndmask_b32 v43, v43, v56, s[28:29]
  s_mov_b32 s45, s44
  v_and_b32 v220, 15, v0
  v_lshlrev_b32 v220, 8, v220
  buffer_load_dwordx4 v[156:159], v2, s[24:27], s45 offen offset:0 sc1
  buffer_load_dwordx4 v[160:163], v2, s[24:27], s45 offen offset:1024 sc1
  buffer_load_dwordx4 v[164:167], v2, s[24:27], s45 offen offset:2048 sc1
  buffer_load_dwordx4 v[168:171], v2, s[24:27], s45 offen offset:3072 sc1
  s_branch attn_main
mega_end:
  s_endpgm
.section .rodata,"a"
.p2align 6
.amdhsa_kernel mega_kernel
  .amdhsa_next_free_vgpr 512
  .amdhsa_next_free_sgpr 96
  .amdhsa_accum_offset 256
  .amdhsa_group_segment_fixed_size 0
  .amdhsa_kernarg_size 80
  .amdhsa_user_sgpr_count 2
  .amdhsa_user_sgpr_kernarg_segment_ptr 1
  .amdhsa_system_sgpr_workgroup_id_x 1
.end_amdhsa_kernel
```
